```python
import torch

def _softmax(x, axis=-1):
    return torch.softmax(x, dim=axis)

def _gelu(x):
    return torch.nn.functional.gelu(x, approximate='tanh')

def _silu(x):
    return torch.nn.functional.silu(x)

def _sigmoid(x):
    return torch.sigmoid(x)

def _layernorm(x, axis=-1, eps=1e-05):
    m = x.mean(dim=axis, keepdim=True)
    v = x.var(dim=axis, keepdim=True, unbiased=False)
    return (x - m) / torch.sqrt(v + eps)

def _scatter_add(tgt, idx, src, axis=0):
    return tgt.clone().index_add_(axis, idx, src)

def _segment_sum(src, seg, n):
    out = torch.zeros((n,) + src.shape[1:], dtype=src.dtype)
    return out.index_add_(0, seg, src)

def _pad(x, pw):
    flat = tuple((v for pair in reversed(pw) for v in pair))
    return torch.nn.functional.pad(x, flat)
kernel_name = 'adaLN_cond__ssm_conv_h3__glu_gated_bilinear__prompt'

def setup_inputs():

    _w = lambda a: (lambda t: t.to(torch.bfloat16) if t.is_floating_point() else t)(torch.as_tensor(a))

    def _A_setup():
        B, S, D = (1, 2048, 448)
        ks = 4
        return {'q': _w((lambda *s: torch.randn(*s, dtype=torch.bfloat16) * 0.05)(B, S, D)), 'k': _w((lambda *s: torch.randn(*s, dtype=torch.bfloat16) * 0.8)(B, S, D)), 'v': _w((lambda *s: torch.randn(*s, dtype=torch.bfloat16) * 0.8)(B, S, D)), 'shift_k': _w((lambda *s: torch.randn(*s, dtype=torch.bfloat16) * 0.8)(D, ks) * 0.5), 'ssm_k': _w((lambda *s: torch.randn(*s, dtype=torch.bfloat16) * 0.8)(D, S) * (1.0 / S ** 0.5)), 'ssm_D': _w((lambda *s: torch.randn(*s, dtype=torch.bfloat16) * 0.8)(D))}
    _A_in = _A_setup()

    def _B_setup():
        B, S, D, F = (1, 2048, 448, 1792)
        return {'x': _w((lambda *s: torch.randn(*s, dtype=torch.bfloat16) * 0.05)(B, S, D)), 'w_gate': _w((lambda *s: torch.randn(*s, dtype=torch.bfloat16) * 0.8)(D, F) * D ** (-0.5)), 'w_up': _w((lambda *s: torch.randn(*s, dtype=torch.bfloat16) * 0.8)(D, F) * D ** (-0.5)), 'w_down': _w((lambda *s: torch.randn(*s, dtype=torch.bfloat16) * 0.8)(F, D) * F ** (-0.5))}
    _B_in = _B_setup()
    return {'A_q': _A_in['q'], 'A_k': _A_in['k'], 'A_v': _A_in['v'], 'A_shift_k': _A_in['shift_k'], 'A_ssm_k': _A_in['ssm_k'], 'A_ssm_D': _A_in['ssm_D'], 'B_x': _B_in['x'], 'B_w_gate': _B_in['w_gate'], 'B_w_up': _B_in['w_up'], 'B_w_down': _B_in['w_down'], 'c': _w((lambda *s: torch.randn(*s, dtype=torch.bfloat16) * 0.2)(1, 448) * 8.0), 'w_mod': _w((lambda *s: torch.randn(*s, dtype=torch.bfloat16) * 0.2)(448, 6 * 448) * 448 ** (-0.5) * 8.0)}

def reference(A_q, A_k, A_v, A_shift_k, A_ssm_k, A_ssm_D, B_x, B_w_gate, B_w_up, B_w_down, c, w_mod):

    def _A_ref(q, k, v, shift_k, ssm_k, ssm_D):
        B, S, D = q.shape
        ks = shift_k.shape[-1]
        k_pad = _pad(k, ((0, 0), (ks - 1, 0), (0, 0)))
        k_shift = torch.zeros_like(k)
        for t in range(ks):
            k_shift = k_shift + k_pad[:, t:t + S, :] * shift_k[:, ks - 1 - t][None, None, :]
        kv = k_shift * v
        L = 2 * S
        kv_pad = _pad(kv, ((0, 0), (0, S), (0, 0)))
        kf_pad = _pad(ssm_k, ((0, 0), (0, S)))
        kv_f = (lambda x, axes=(-2, -1): torch.fft.rfft2(x.float(), dim=axes))(kv_pad[:, None, :, :], axes=(1, 2))
        kf_f = (lambda x, axes=(-2, -1): torch.fft.rfft2(x.float(), dim=axes))(kf_pad[:, None, :], axes=(1, 2))
        kf_f = (lambda x, *d: x.permute(*d))(kf_f, 1, 2, 0)
        y_f = kv_f * kf_f[None, :, :, :]
        y = (lambda x, s, axes=(-2, -1): torch.fft.irfft2(x, s=s, dim=axes).to(torch.bfloat16))(y_f, (1, L), axes=(1, 2))[:, 0, :S, :]
        y = y + kv * ssm_D[None, None, :]
        return q * y

    def _B_ref(x, w_gate, w_up, w_down):
        g = torch.einsum('bsd,df->bsf', x, w_gate)
        u = torch.einsum('bsd,df->bsf', x, w_up)
        h = g * u
        return torch.einsum('bsf,fd->bsd', h, w_down)
    x = A_q
    mod = (_silu(c) @ w_mod).reshape(c.shape[0], 6, 1, -1)
    sa, ca, ga, sb, cb, gb = (mod[:, 0].clone(), mod[:, 1].clone(), mod[:, 2].clone(), mod[:, 3].clone(), mod[:, 4].clone(), mod[:, 5].clone())
    h = _layernorm(x, axis=-1) * (1 + ca) + sa
    x = x + ga * _A_ref(h, A_k, A_v, A_shift_k, A_ssm_k, A_ssm_D)
    h = _layernorm(x, axis=-1) * (1 + cb) + sb
    x = x + gb * _B_ref(h, B_w_gate, B_w_up, B_w_down)
    return x
```

```asm
; @launch grid=(256,1,1) block=(256,1,1) lds=163840
.amdgcn_target "amdgcn-amd-amdhsa--gfx950"
.text
.globl adaLN_cond__ssm_conv_h3__glu_gated_bilinear__prompt_kernel
.p2align 12
.p2align 8
.type adaLN_cond__ssm_conv_h3__glu_gated_bilinear__prompt_kernel,@function
adaLN_cond__ssm_conv_h3__glu_gated_bilinear__prompt_kernel:
    s_lshr_b32 s53, s2, 3
    s_cmp_ge_u32 s53, 32
    s_cbranch_scc1 L_end
    s_load_dwordx16 s[56:71], s[0:1], 0
    s_load_dwordx2 s[4:5], s[0:1], 112
    s_load_dwordx8 s[72:79], s[0:1], 64
    s_load_dwordx2 s[40:41], s[0:1], 96
    s_mov_b32 s7, 0x20000
    s_getpc_b64 s[44:45]
L_pc:
    s_add_u32 s44, s44, L_page-L_pc
    s_addc_u32 s45, s45, 0
    s_mov_b32 s46, 0x8000
    s_mov_b32 s47, s7
    v_lshrrev_b32 v2, 5, v0
    v_lshlrev_b32 v2, 12, v2
    s_lshl_b32 s52, s53, 7
    s_mov_b32 exec_lo, 1
    s_mov_b32 exec_hi, 1
    buffer_load_dword v3, v2, s[44:47], s52 offen
    s_mov_b64 exec, -1
    v_lshrrev_b32 v2, 6, v0
    v_and_b32 v1, 63, v0
    s_and_b32 s52, s2, 7
    v_readfirstlane_b32 s3, v2
    s_mul_i32 s54, s53, 37
    s_lshr_b32 s54, s54, 8
    s_mul_i32 s55, s54, 7
    s_sub_u32 s55, s53, s55
    s_cmp_lt_u32 s53, 28
    s_cbranch_scc1 L_worker
    v_lshlrev_b32 v4, 2, v0
    v_lshrrev_b32 v14, 4, v0
    v_and_b32 v15, 15, v0
    v_mul_u32_u24 v8, 336, v14
    v_add_lshl_u32 v8, v8, v15, 4
    s_sub_u32 s48, s2, 224
    s_lshl_b32 s49, s48, 8
    s_mov_b32 s44, s49
    s_movk_i32 s18, 896
    s_mov_b32 s19, s7
    s_mov_b32 s22, 2408448
    s_mov_b32 s23, s7
    s_mov_b32 s46, 86016
    s_waitcnt lgkmcnt(0)
    s_mov_b64 s[16:17], s[76:77]
    s_mov_b64 s[20:21], s[78:79]
    s_load_dwordx2 s[50:51], s[4:5], 0
    s_cmp_ge_u32 s48, 21
    s_cbranch_scc1 L_h_free
    buffer_load_dword v5, v4, s[16:19], 0 offen
    buffer_load_dwordx4 v[128:131], v8, s[20:23], s44 offen
    s_add_u32 s44, s44, s46
    buffer_load_dwordx4 v[132:135], v8, s[20:23], s44 offen
    s_add_u32 s44, s44, s46
    buffer_load_dwordx4 v[136:139], v8, s[20:23], s44 offen
    s_add_u32 s44, s44, s46
    buffer_load_dwordx4 v[140:143], v8, s[20:23], s44 offen
    s_add_u32 s44, s44, s46
    buffer_load_dwordx4 v[144:147], v8, s[20:23], s44 offen
    s_add_u32 s44, s44, s46
    buffer_load_dwordx4 v[148:151], v8, s[20:23], s44 offen
    s_add_u32 s44, s44, s46
    buffer_load_dwordx4 v[152:155], v8, s[20:23], s44 offen
    s_add_u32 s44, s44, s46
    buffer_load_dwordx4 v[156:159], v8, s[20:23], s44 offen
    s_add_u32 s44, s44, s46
    buffer_load_dwordx4 v[160:163], v8, s[20:23], s44 offen
    s_add_u32 s44, s44, s46
    buffer_load_dwordx4 v[164:167], v8, s[20:23], s44 offen
    s_add_u32 s44, s44, s46
    s_branch L_helper
L_worker:
    s_lshl_b32 s48, s52, 2
    s_add_u32 s48, s48, s54
    v_lshrrev_b32 v4, 3, v1
    v_and_b32 v5, 7, v1
    v_mul_u32_u24 v6, 56, v4
    v_add_lshl_u32 v6, v6, v5, 4
    s_mul_i32 s49, s48, 57344
    s_lshl_b32 s46, s55, 7
    s_add_u32 s49, s49, s46
    s_movk_i32 s44, 7168
    s_sub_u32 s45, s49, s44
    s_cselect_b32 s45, 0x80000000, s45
    s_mul_i32 s46, s3, s44
    s_lshl1_add_u32 s49, s46, s49
    s_add_u32 s44, s44, s49
    s_mul_i32 s46, s3, 2080
    s_mov_b32 m0, 131584
    s_mov_b32 s10, 1835008
    s_mov_b32 s11, s7
    s_mov_b32 s14, s10
    s_mov_b32 s15, s7
    s_waitcnt lgkmcnt(0)
    s_mov_b64 s[8:9], s[58:59]
    s_mov_b64 s[12:13], s[60:61]
    s_cmp_lg_u32 s3, 0
    s_cbranch_scc1 L_nohalo
    buffer_load_dwordx4 v6, s[8:11], s45 offen lds
L_nohalo:
    s_add_u32 m0, s46, 132624
    s_movk_i32 s45, 1040
    buffer_load_dwordx4 v6, s[8:11], s49 offen lds
    s_add_u32 m0, m0, s45
    s_lshl_b32 s46, s3, 3
    buffer_load_dwordx4 v6, s[8:11], s44 offen lds
    s_add_u32 m0, m0, 7280
    s_mov_b64 s[16:17], s[62:63]
    buffer_load_dwordx4 v6, s[12:15], s49 offen lds
    s_add_u32 m0, m0, s45
    s_movk_i32 s18, 3584
    buffer_load_dwordx4 v6, s[12:15], s44 offen lds
    s_load_dwordx2 s[50:51], s[4:5], 0
    s_mul_i32 s47, s52, 28
    s_add_u32 s47, s47, s53
    s_lshl_b32 s49, s47, 2
    s_load_dword s66, s[66:67], s49
    s_mov_b32 s19, s7
    v_add_lshl_u32 v8, v4, s46, 4
    s_lshl_b32 s49, s55, 9
    buffer_load_dwordx4 v[52:55], v8, s[16:19], s49 offen
    s_lshl_b32 s49, s55, 2
    s_add_u32 s49, s49, s3
    s_mul_i32 s49, s49, 73728
    s_lshl_b32 s45, s48, 7
    s_add_u32 s49, s49, s45
    s_bitset1_b32 s49, 21
    s_add_u32 s45, s49, 36864
    v_mul_u32_u24 v12, 288, v4
    v_add_lshl_u32 v12, v12, v5, 4
    v_mov_b32 v120, -1
    v_mov_b32 v121, -1
    v_mov_b32 v122, -1
    v_mov_b32 v123, -1
    s_mov_b32 s6, 18874368
    buffer_store_dwordx4 v[120:123], v12, s[4:7], s49 offen sc1
    buffer_store_dwordx4 v[120:123], v12, s[4:7], s45 offen sc1
    v_mul_u32_u24 v9, 576, v4
    v_add_lshl_u32 v9, v9, v5, 4
    v_add_u32 v9, s49, v9
    v_add_u32 v10, 4608, v9
    v_add_u32 v4, s46, v4
    v_lshlrev_b32 v11, 4, v1
    s_mov_b64 s[24:25], s[56:57]
    s_mov_b64 s[28:29], s[70:71]
    s_mov_b64 s[32:33], s[72:73]
    s_mov_b64 s[36:37], s[74:75]
    s_mov_b32 s26, 1835008
    s_mov_b32 s27, s7
    s_mov_b32 s30, 1605632
    s_mov_b32 s31, s7
    s_mov_b32 s34, s30
    s_mov_b32 s35, s7
    s_mov_b32 s38, s30
    s_mov_b32 s39, s7
    s_mov_b32 s42, s26
    s_mov_b32 s43, s7
    s_and_b32 s57, s53, 7
    s_lshl_b32 s57, s57, 5
    s_and_b32 s58, s53, 24
    s_add_u32 s57, s57, s58
    s_lshl_b32 s58, s52, 8
    s_add_u32 s57, s57, s58
    s_lshr_b32 s58, s3, 1
    s_add_u32 s57, s57, s58
    s_and_b32 s58, s3, 1
    s_lshl_b32 s58, s58, 2
    s_add_u32 s57, s57, s58
    v_lshrrev_b32 v2, 5, v1
    v_lshl_add_u32 v2, v2, 1, s57
    v_and_b32 v24, 31, v1
    v_bfe_u32 v25, v2, 1, 3
    v_mul_u32_u24 v2, 896, v2
    v_xor_b32 v25, v25, v24
    v_lshl_add_u32 v26, v24, 4, v2
    v_lshl_add_u32 v28, v25, 4, v2
    v_cmp_gt_u32 vcc, 24, v24
    v_mov_b32 v25, 0x80000000
    v_add_u32 v27, 512, v26
    v_add_u32 v29, 512, v28
    v_cndmask_b32 v27, v25, v27, vcc
    v_cndmask_b32 v29, v25, v29, vcc
    s_mov_b64 s[20:21], s[64:65]
    s_mov_b32 s22, 1835008
    s_mov_b32 s23, s7
    s_mov_b32 s56, s47
    s_sub_u32 s32, s32, 1024
    s_subb_u32 s33, s33, 0
    s_mov_b32 s34, 1606656
    s_lshr_b32 s64, s3, 1
    s_and_b32 s65, s3, 1
    s_lshl_b32 s57, s56, 1
    s_add_u32 s57, s57, s64
    s_lshl_b32 s57, s57, 12
    s_mul_i32 s58, s3, 4224
    s_lshl_b32 s59, s65, 2
    s_add_u32 s59, s59, s58
    s_add_u32 m0, s59, 114752
    s_add_u32 s58, s58, 114688
    s_mov_b32 s44, s57
    s_mul_i32 s57, s56, 9216
    s_lshl_b32 s59, s3, 10
    s_add_u32 s57, s57, s59
    s_add_u32 s57, s57, 2097152
    v_add_u32 v12, s57, v11
    v_add_u32 v13, 4608, v12
    s_add_u32 s59, s65, 15
    v_min_u32 v14, s59, v1
    v_lshl_add_u32 v14, v14, 2, s58
    v_mov_b32 v104, 0
    ds_write_b32 v14, v104
    s_and_b32 s13, s52, 3
    s_mul_i32 s13, s13, 28
    s_add_u32 s13, s13, s53
    s_and_b32 s12, s13, 7
    s_and_b32 s0, s52, 4
    s_lshl1_add_u32 s12, s0, s12
    s_lshr_b32 s13, s13, 3
    s_and_b32 s0, s53, 1
    s_cmp_ge_u32 s13, 7
    s_cselect_b32 s57, 1, 0
    s_mul_i32 s14, s57, 7
    s_sub_u32 s14, s13, s14
    s_lshl2_add_u32 s15, s12, s57
    v_mul_u32_u24 v16, 1040, v5
    v_lshl_add_u32 v16, v4, 2, v16
    v_add_u32 v16, 131584, v16
    v_add_u32 v17, 1040, v16
    v_add_u32 v18, 9360, v16
    s_lshl_b32 s61, s13, 13
    s_lshl_b32 s57, s13, 8
    s_mul_i32 s58, s3, 14336
    s_add_u32 s57, s57, s58
    v_bfe_u32 v14, v1, 2, 2
    v_mul_u32_u24 v20, 3584, v14
    v_lshrrev_b32 v15, 4, v1
    v_lshl_add_u32 v20, v15, 6, v20
    v_and_b32 v15, 3, v1
    v_lshl_add_u32 v20, v15, 4, v20
    v_add_u32 v20, s57, v20
    v_lshlrev_b32 v21, 6, v14
    v_lshl_add_u32 v21, v15, 3, v21
    v_bfe_u32 v15, v1, 4, 1
    v_lshl_add_u32 v21, v15, 5, v21
    v_mov_b32 v23, v21
    v_lshrrev_b32 v15, 5, v1
    v_lshl_add_u32 v21, v15, 12, v21
    v_lshl_add_u32 v23, v15, 8, v23
    s_lshl_b32 s57, s3, 8
    v_add_u32 v21, s57, v21
    v_add_u32 v22, 57344, v21
    s_mul_i32 s57, s3, 12288
    s_add_u32 s57, s57, 114688
    v_add_u32 v23, s57, v23
    s_mul_i32 s0, s0, 802816
    s_sub_u32 s1, 802816, s0
    s_lshl_b32 s60, s3, 11
    s_add_u32 s61, s61, s60
    s_mul_i32 s57, s12, 458752
    s_add_u32 s61, s61, s57
    s_add_u32 s61, s61, 10485760
    s_lshl_b32 s57, s55, 2
    s_add_u32 s57, s57, s3
    s_lshl_b32 s57, s57, 5
    s_add_u32 s57, s57, s48
    s_lshl_b32 s57, s57, 5
    s_add_u32 s57, s57, 262144
    v_add_u32 v14, s57, v11
    s_lshr_b32 s57, s56, 3
    s_lshl_b32 s57, s57, 10
    s_add_u32 s57, s57, 262144
    v_lshrrev_b32 v15, 3, v0
    v_lshl_add_u32 v15, v15, 5, s57
    s_lshl_b32 s57, s64, 5
    v_xor_b32 v20, s57, v20
    v_lshrrev_b32 v22, 5, v1
    v_bfe_u32 v19, v1, 4, 1
    v_add_lshl_u32 v22, v22, v19, 12
    v_add_u32 v21, v21, v22
    v_xor_b32 v22, 32, v21
    s_lshl2_add_u32 s57, s13, s3
    s_lshl_b32 s57, s57, 10
    s_sub_u32 s61, s61, s57
    s_waitcnt lgkmcnt(0)
    s_mov_b32 s49, s66
    s_add_u32 s50, s50, 1
    s_addc_u32 s51, s51, 0
    v_mov_b32 v124, s50
    v_mov_b32 v125, s51
    s_waitcnt vmcnt(6)
    buffer_load_dwordx4 v11, s[20:23], s44 offen offset:0 lds
    buffer_load_dwordx4 v11, s[20:23], s44 offen offset:1024 lds
    buffer_load_dwordx4 v11, s[20:23], s44 offen offset:2048 lds
    buffer_load_dwordx4 v11, s[20:23], s44 offen offset:3072 lds
    buffer_load_dwordx4 v[112:115], v26, s[24:27], 0 offen
    buffer_load_dwordx4 v[116:119], v27, s[24:27], 0 offen
    s_waitcnt vmcnt(8)
    s_barrier
    ds_read2_b32 v[32:33], v16 offset0:160 offset1:192
    ds_read_b32 v34, v16 offset:896
    ds_read2_b32 v[36:37], v17 offset0:0 offset1:32
    ds_read2_b32 v[38:39], v17 offset0:64 offset1:96
    ds_read2_b32 v[40:41], v17 offset0:128 offset1:160
    ds_read2_b32 v[42:43], v17 offset0:192 offset1:224
    ds_read2_b32 v[44:45], v18 offset0:0 offset1:32
    ds_read2_b32 v[46:47], v18 offset0:64 offset1:96
    ds_read2_b32 v[48:49], v18 offset0:128 offset1:160
    ds_read2_b32 v[50:51], v18 offset0:192 offset1:224
    s_waitcnt vmcnt(6)
    s_mov_b64 exec, 1
    buffer_store_dwordx2 v[124:125], v14, s[4:7], 0 offen sc1
    s_mov_b64 exec, -1
    v_lshlrev_b32 v56, 16, v52
    v_lshlrev_b32 v57, 16, v54
    v_and_b32 v58, 0xffff0000, v52
    v_and_b32 v59, 0xffff0000, v54
    v_lshlrev_b32 v60, 16, v53
    v_lshlrev_b32 v61, 16, v55
    v_and_b32 v62, 0xffff0000, v53
    v_and_b32 v63, 0xffff0000, v55
    s_waitcnt lgkmcnt(8)
    v_lshlrev_b32 v64, 16, v32
    v_and_b32 v65, 0xffff0000, v32
    v_lshlrev_b32 v66, 16, v33
    v_and_b32 v67, 0xffff0000, v33
    v_lshlrev_b32 v68, 16, v34
    v_and_b32 v69, 0xffff0000, v34
    s_waitcnt lgkmcnt(7)
    v_lshlrev_b32 v70, 16, v36
    v_and_b32 v71, 0xffff0000, v36
    v_lshlrev_b32 v72, 16, v37
    v_and_b32 v73, 0xffff0000, v37
    s_waitcnt lgkmcnt(6)
    v_lshlrev_b32 v74, 16, v38
    v_and_b32 v75, 0xffff0000, v38
    v_lshlrev_b32 v76, 16, v39
    v_and_b32 v77, 0xffff0000, v39
    s_waitcnt lgkmcnt(5)
    v_lshlrev_b32 v78, 16, v40
    v_and_b32 v79, 0xffff0000, v40
    v_lshlrev_b32 v80, 16, v41
    v_and_b32 v81, 0xffff0000, v41
    s_waitcnt lgkmcnt(4)
    v_lshlrev_b32 v82, 16, v42
    v_and_b32 v83, 0xffff0000, v42
    v_lshlrev_b32 v84, 16, v43
    v_and_b32 v85, 0xffff0000, v43
    v_pk_mul_f32 v[86:87], v[70:71], v[56:57]
    v_pk_mul_f32 v[88:89], v[72:73], v[56:57]
    v_pk_mul_f32 v[90:91], v[74:75], v[56:57]
    v_pk_mul_f32 v[92:93], v[76:77], v[56:57]
    v_pk_mul_f32 v[94:95], v[78:79], v[56:57]
    v_pk_mul_f32 v[96:97], v[80:81], v[56:57]
    v_pk_mul_f32 v[98:99], v[82:83], v[56:57]
    v_pk_mul_f32 v[100:101], v[84:85], v[56:57]
    v_pk_fma_f32 v[86:87], v[68:69], v[58:59], v[86:87]
    v_pk_fma_f32 v[88:89], v[70:71], v[58:59], v[88:89]
    v_pk_fma_f32 v[90:91], v[72:73], v[58:59], v[90:91]
    v_pk_fma_f32 v[92:93], v[74:75], v[58:59], v[92:93]
    v_pk_fma_f32 v[94:95], v[76:77], v[58:59], v[94:95]
    v_pk_fma_f32 v[96:97], v[78:79], v[58:59], v[96:97]
    v_pk_fma_f32 v[98:99], v[80:81], v[58:59], v[98:99]
    v_pk_fma_f32 v[100:101], v[82:83], v[58:59], v[100:101]
    v_pk_fma_f32 v[86:87], v[66:67], v[60:61], v[86:87]
    v_pk_fma_f32 v[88:89], v[68:69], v[60:61], v[88:89]
    v_pk_fma_f32 v[90:91], v[70:71], v[60:61], v[90:91]
    v_pk_fma_f32 v[92:93], v[72:73], v[60:61], v[92:93]
    v_pk_fma_f32 v[94:95], v[74:75], v[60:61], v[94:95]
    v_pk_fma_f32 v[96:97], v[76:77], v[60:61], v[96:97]
    v_pk_fma_f32 v[98:99], v[78:79], v[60:61], v[98:99]
    v_pk_fma_f32 v[100:101], v[80:81], v[60:61], v[100:101]
    v_pk_fma_f32 v[86:87], v[64:65], v[62:63], v[86:87]
    v_pk_fma_f32 v[88:89], v[66:67], v[62:63], v[88:89]
    v_pk_fma_f32 v[90:91], v[68:69], v[62:63], v[90:91]
    v_pk_fma_f32 v[92:93], v[70:71], v[62:63], v[92:93]
    v_pk_fma_f32 v[94:95], v[72:73], v[62:63], v[94:95]
    v_pk_fma_f32 v[96:97], v[74:75], v[62:63], v[96:97]
    v_pk_fma_f32 v[98:99], v[76:77], v[62:63], v[98:99]
    v_pk_fma_f32 v[100:101], v[78:79], v[62:63], v[100:101]
    s_waitcnt lgkmcnt(0)
    v_lshlrev_b32 v64, 16, v44
    v_and_b32 v65, 0xffff0000, v44
    v_lshlrev_b32 v66, 16, v45
    v_and_b32 v67, 0xffff0000, v45
    v_lshlrev_b32 v68, 16, v46
    v_and_b32 v69, 0xffff0000, v46
    v_lshlrev_b32 v70, 16, v47
    v_and_b32 v71, 0xffff0000, v47
    v_lshlrev_b32 v72, 16, v48
    v_and_b32 v73, 0xffff0000, v48
    v_lshlrev_b32 v74, 16, v49
    v_and_b32 v75, 0xffff0000, v49
    v_lshlrev_b32 v76, 16, v50
    v_and_b32 v77, 0xffff0000, v50
    v_lshlrev_b32 v78, 16, v51
    v_and_b32 v79, 0xffff0000, v51
    v_pk_mul_f32 v[86:87], v[86:87], v[64:65]
    v_pk_mul_f32 v[88:89], v[88:89], v[66:67]
    v_pk_mul_f32 v[90:91], v[90:91], v[68:69]
    v_pk_mul_f32 v[92:93], v[92:93], v[70:71]
    v_pk_mul_f32 v[94:95], v[94:95], v[72:73]
    v_pk_mul_f32 v[96:97], v[96:97], v[74:75]
    v_pk_mul_f32 v[98:99], v[98:99], v[76:77]
    v_pk_mul_f32 v[100:101], v[100:101], v[78:79]
    v_cvt_pk_bf16_f32 v104, v100, v98
    v_cvt_pk_bf16_f32 v105, v96, v94
    v_cvt_pk_bf16_f32 v106, v92, v90
    v_cvt_pk_bf16_f32 v107, v88, v86
    v_and_b32 v104, -2, v104
    v_and_b32 v105, -2, v105
    v_and_b32 v106, -2, v106
    v_and_b32 v107, -2, v107
    buffer_store_dwordx4 v[104:107], v9, s[4:7], 0 offen sc1
    v_cvt_pk_bf16_f32 v108, v101, v99
    v_cvt_pk_bf16_f32 v109, v97, v95
    v_cvt_pk_bf16_f32 v110, v93, v91
    v_cvt_pk_bf16_f32 v111, v89, v87
    v_and_b32 v108, -2, v108
    v_and_b32 v109, -2, v109
    v_and_b32 v110, -2, v110
    v_and_b32 v111, -2, v111
    buffer_store_dwordx4 v[108:111], v10, s[4:7], 0 offen sc1
    s_mul_i32 s58, s56, 9216
    s_add_u32 s62, s58, 2097152
    s_add_u32 s63, s62, 4608
    v_and_b32 v36, 7, v0
    v_bfe_u32 v37, v0, 3, 2
    v_lshrrev_b32 v38, 5, v0
    v_lshl_add_u32 v39, v36, 2, v37
    v_lshl_add_u32 v39, v38, 5, v39
    v_lshlrev_b32 v30, 4, v39
    v_and_b32 v4, 15, v1
    v_lshrrev_b32 v5, 4, v1
    v_and_b32 v2, 1, v1
    v_xor_b32 v2, 1, v2
    v_mul_u32_u24 v46, 4228, v2
    v_lshl_add_u32 v46, v4, 2, v46
    v_lshl_add_u32 v46, v5, 4, v46
    s_mul_i32 s57, s64, 8448
    s_lshl_b32 s58, s65, 8
    s_add_u32 s57, s57, s58
    s_add_u32 s57, s57, 114692
    v_add_u32 v46, s57, v46
    v_mov_b32 v32, 0
    v_mov_b32 v33, 0
    v_mov_b32 v34, 0
    v_mov_b32 v35, 0
    s_mul_i32 s57, s65, 12288
    s_add_u32 s57, s57, 142336
    v_add_u32 v44, s57, v11
    v_mov_b32 v45, s57
    v_lshlrev_b32 v9, 4, v36
    v_lshl_add_u32 v9, v37, 8, v9
    v_lshl_add_u32 v9, v38, 10, v9
    v_add_u32 v9, 143360, v9
    v_add_u32 v39, 1, v39
    v_bfe_u32 v10, v39, 2, 3
    v_lshlrev_b32 v10, 4, v10
    v_and_b32 v36, 3, v39
    v_lshl_add_u32 v10, v36, 8, v10
    v_lshrrev_b32 v36, 5, v39
    v_lshl_add_u32 v10, v36, 10, v10
    v_add_u32 v10, 143502, v10
    v_cmp_eq_u32 vcc, 0xff, v0
    v_mov_b32 v36, 141312
    s_mul_i32 s57, s64, 12288
    v_cndmask_b32 v10, v10, v36, vcc
    s_add_u32 s57, s57, 144128
    v_lshlrev_b32 v36, 7, v2
    v_lshlrev_b32 v37, 8, v5
    v_sub_u32 v38, v36, v37
    v_add_u32 v38, s57, v38
    v_lshrrev_b32 v39, 1, v4
    v_add_u32 v36, v36, v37
    v_lshl_add_u32 v25, v39, 4, v36
    s_lshl_b32 s57, s3, 10
    s_add_u32 s58, s57, 143360
    v_add_u32 v25, s58, v25
    s_add_u32 s58, s57, 114688
    v_add_u32 v3, s58, v11
    s_lshl_b32 s57, s3, 12
    s_add_u32 s57, s57, 114688
    v_add_u32 v2, s57, v11
    s_cmp_eq_u32 s3, 3
    s_cselect_b32 s58, 0x2000, 0
    s_add_u32 s58, s58, 0x4000
    v_add_u32 v31, s58, v2
    s_lshl_b32 s57, s65, 2
    v_subrev_u32 v39, s57, v39
    v_ashrrev_i32 v36, 3, v39
    v_and_b32 v37, 7, v39
    v_lshl_add_u32 v16, v36, 10, v38
    v_lshl_add_u32 v16, v37, 4, v16
    v_subrev_u32 v39, 1, v39
    v_ashrrev_i32 v36, 3, v39
    v_and_b32 v37, 7, v39
    v_lshl_add_u32 v17, v36, 10, v38
    v_lshl_add_u32 v17, v37, 4, v17
    v_subrev_u32 v39, 1, v39
    v_ashrrev_i32 v36, 3, v39
    v_and_b32 v37, 7, v39
    v_lshl_add_u32 v18, v36, 10, v38
    v_lshl_add_u32 v18, v37, 4, v18
    v_subrev_u32 v39, 1, v39
    v_ashrrev_i32 v36, 3, v39
    v_and_b32 v37, 7, v39
    v_lshl_add_u32 v19, v36, 10, v38
    v_lshl_add_u32 v19, v37, 4, v19
    s_lshl_b32 s57, s2, 5
    s_add_u32 s57, s57, 393216
    s_cmp_eq_u32 s3, 0
    s_cselect_b32 s57, s57, 0x80000000
    v_add_u32 v14, s57, v11
    s_waitcnt vmcnt(3)
    v_lshlrev_b32 v64, 16, v112
    v_and_b32 v65, 0xffff0000, v112
    v_lshlrev_b32 v66, 16, v113
    v_and_b32 v67, 0xffff0000, v113
    v_lshlrev_b32 v68, 16, v114
    v_and_b32 v69, 0xffff0000, v114
    v_lshlrev_b32 v70, 16, v115
    v_and_b32 v71, 0xffff0000, v115
    v_lshlrev_b32 v72, 16, v116
    v_and_b32 v73, 0xffff0000, v116
    v_lshlrev_b32 v74, 16, v117
    buffer_load_dwordx2 v[126:127], v15, s[4:7], 0 offen sc1
    s_branch L_page
.p2align 12
L_page:
L_pg1:
    s_cbranch_execz L_warm
    s_add_u32 m0, s60, 0
    s_add_u32 s59, s0, 0
    buffer_load_dwordx4 v20, s[28:31], s59 offen lds
    v_and_b32 v75, 0xffff0000, v117
    v_lshlrev_b32 v76, 16, v118
    v_and_b32 v77, 0xffff0000, v118
    v_lshlrev_b32 v78, 16, v119
    v_and_b32 v79, 0xffff0000, v119
    v_pk_add_f32 v[6:7], v[64:65], v[66:67]
    buffer_load_dwordx4 v20, s[32:35], s59 offen offset:1024 lds
    v_pk_mul_f32 v[80:81], v[64:65], v[64:65]
    v_pk_fma_f32 v[80:81], v[66:67], v[66:67], v[80:81]
    v_pk_add_f32 v[6:7], v[6:7], v[68:69]
    v_pk_fma_f32 v[80:81], v[68:69], v[68:69], v[80:81]
    v_pk_add_f32 v[6:7], v[6:7], v[70:71]
    v_pk_fma_f32 v[80:81], v[70:71], v[70:71], v[80:81]
    s_add_u32 m0, s60, 8192
    s_add_u32 s59, s0, 57344
    buffer_load_dwordx4 v20, s[28:31], s59 offen lds
    v_pk_add_f32 v[6:7], v[6:7], v[72:73]
    v_pk_fma_f32 v[80:81], v[72:73], v[72:73], v[80:81]
    v_pk_add_f32 v[6:7], v[6:7], v[74:75]
    v_pk_fma_f32 v[80:81], v[74:75], v[74:75], v[80:81]
    v_pk_add_f32 v[6:7], v[6:7], v[76:77]
    v_pk_fma_f32 v[80:81], v[76:77], v[76:77], v[80:81]
    buffer_load_dwordx4 v20, s[32:35], s59 offen offset:1024 lds
    v_pk_add_f32 v[6:7], v[6:7], v[78:79]
    v_pk_fma_f32 v[80:81], v[78:79], v[78:79], v[80:81]
    v_add_f32 v6, v6, v7
    v_add_f32 v80, v80, v81
    s_nop 1
    v_permlane16_swap_b32 v6, v80
    v_add_f32 v6, v6, v80
    s_add_u32 m0, s60, 16384
    s_add_u32 s59, s0, 114688
    buffer_load_dwordx4 v20, s[28:31], s59 offen lds
    v_add_f32_dpp v6, v6, v6 quad_perm:[1,0,3,2] row_mask:0xf bank_mask:0xf
    s_nop 1
    v_add_f32_dpp v6, v6, v6 quad_perm:[2,3,0,1] row_mask:0xf bank_mask:0xf
    s_nop 1
    v_add_f32_dpp v6, v6, v6 row_half_mirror row_mask:0xf bank_mask:0xf
    s_nop 1
    v_add_f32_dpp v6, v6, v6 row_mirror row_mask:0xf bank_mask:0xf
    v_mul_f32 v7, 0x3b124925, v6
    v_mul_f32 v80, 0x3b124925, v6
    buffer_load_dwordx4 v20, s[32:35], s59 offen offset:1024 lds
    s_nop 0
    v_permlane16_swap_b32 v7, v80
    v_fma_f32 v80, -v7, v7, v80
    v_max_f32 v80, 0, v80
    v_add_f32 v80, 0x3727c5ac, v80
    v_rsq_f32 v6, v80
    s_nop 0
    v_mul_f32_e64 v7, -v7, v6
    s_mov_b64 exec, 0
    s_cmp_eq_u32 s3, 0
    s_cbranch_scc1 L_pg2
    s_cmp_eq_u32 s3, 1
    s_cbranch_scc1 L_pg3
    s_cmp_eq_u32 s3, 2
    s_cbranch_scc1 L_pg4
    s_branch L_pg5
L_warm:
    s_mov_b64 exec, -1
    s_waitcnt vmcnt(6)
    v_cmp_ne_u64 vcc, s[50:51], v[126:127]
    s_cbranch_vccnz L_fa_retry
L_fa_ok:
    buffer_load_dwordx4 v[104:107], v30, s[4:7], s62 offen sc1
    buffer_load_dwordx4 v[108:111], v30, s[4:7], s63 offen sc1
    s_barrier
    s_add_u32 m0, s60, 24576
    s_add_u32 s59, s0, 172032
    buffer_load_dwordx4 v20, s[28:31], s59 offen lds
    ds_write_b128 v44, v[32:35]
    ds_write_b16 v45, v32 offset:1166
    ds_read_b64 v[128:129], v46 offset:0
    ds_read_b64 v[130:131], v46 offset:8
    ds_read_b64 v[132:133], v46 offset:64
    buffer_load_dwordx4 v20, s[32:35], s59 offen offset:1024 lds
    ds_read_b64 v[134:135], v46 offset:72
    ds_read_b64 v[136:137], v46 offset:128
    ds_read_b64 v[138:139], v46 offset:136
    ds_read_b64 v[140:141], v46 offset:192
    ds_read_b64 v[142:143], v46 offset:200
    s_add_u32 m0, s60, 32768
    s_add_u32 s59, s0, 229376
    buffer_load_dwordx4 v20, s[28:31], s59 offen lds
    ds_read_b64 v[144:145], v46 offset:512
    ds_read_b64 v[146:147], v46 offset:520
    ds_read_b64 v[148:149], v46 offset:576
    ds_read_b64 v[150:151], v46 offset:584
    ds_read_b64 v[152:153], v46 offset:640
    buffer_load_dwordx4 v20, s[32:35], s59 offen offset:1024 lds
    ds_read_b64 v[154:155], v46 offset:648
    ds_read_b64 v[156:157], v46 offset:704
    ds_read_b64 v[158:159], v46 offset:712
    ds_read_b64 v[160:161], v46 offset:1024
    ds_read_b64 v[162:163], v46 offset:1032
    ds_read_b64 v[164:165], v46 offset:1088
    s_add_u32 m0, s60, 40960
    s_add_u32 s59, s0, 286720
    buffer_load_dwordx4 v20, s[28:31], s59 offen lds
    ds_read_b64 v[166:167], v46 offset:1096
    ds_read_b64 v[168:169], v46 offset:1152
    ds_read_b64 v[170:171], v46 offset:1160
    ds_read_b64 v[172:173], v46 offset:1216
    ds_read_b64 v[174:175], v46 offset:1224
    buffer_load_dwordx4 v20, s[32:35], s59 offen offset:1024 lds
    ds_read_b64 v[176:177], v46 offset:1536
    ds_read_b64 v[178:179], v46 offset:1544
    ds_read_b64 v[180:181], v46 offset:1600
    ds_read_b64 v[182:183], v46 offset:1608
    ds_read_b64 v[184:185], v46 offset:1664
    s_add_u32 m0, s60, 49152
    s_add_u32 s59, s0, 344064
    buffer_load_dwordx4 v20, s[28:31], s59 offen lds
    ds_read_b64 v[186:187], v46 offset:1672
    ds_read_b64 v[188:189], v46 offset:1728
    ds_read_b64 v[190:191], v46 offset:1736
    ds_read_b64 v[192:193], v46 offset:2048
    ds_read_b64 v[194:195], v46 offset:2056
    ds_read_b64 v[196:197], v46 offset:2112
    buffer_load_dwordx4 v20, s[32:35], s59 offen offset:1024 lds
    ds_read_b64 v[198:199], v46 offset:2120
    ds_read_b64 v[200:201], v46 offset:2176
    ds_read_b64 v[202:203], v46 offset:2184
    ds_read_b64 v[204:205], v46 offset:2240
    ds_read_b64 v[206:207], v46 offset:2248
    s_add_u32 m0, s60, 57344
    s_add_u32 s59, s0, 401408
    buffer_load_dwordx4 v20, s[28:31], s59 offen lds
    ds_read_b64 v[208:209], v46 offset:2560
    ds_read_b64 v[210:211], v46 offset:2568
    ds_read_b64 v[212:213], v46 offset:2624
    ds_read_b64 v[214:215], v46 offset:2632
    ds_read_b64 v[216:217], v46 offset:2688
    buffer_load_dwordx4 v20, s[32:35], s59 offen offset:1024 lds
    ds_read_b64 v[218:219], v46 offset:2696
    ds_read_b64 v[220:221], v46 offset:2752
    ds_read_b64 v[222:223], v46 offset:2760
    ds_read_b64 v[224:225], v46 offset:3072
    ds_read_b64 v[226:227], v46 offset:3080
    ds_read_b64 v[228:229], v46 offset:3136
    ds_read_b64 v[230:231], v46 offset:3144
    ds_read_b64 v[232:233], v46 offset:3200
    ds_read_b64 v[234:235], v46 offset:3208
    ds_read_b64 v[236:237], v46 offset:3264
    ds_read_b64 v[238:239], v46 offset:3272
    ds_read_b64 v[240:241], v46 offset:3584
    ds_read_b64 v[242:243], v46 offset:3592
    ds_read_b64 v[244:245], v46 offset:3648
    ds_read_b64 v[246:247], v46 offset:3656
    ds_read_b64 v[248:249], v46 offset:3712
    ds_read_b64 v[250:251], v46 offset:3720
    ds_read_b64 v[252:253], v46 offset:3776
    ds_read_b64 v[254:255], v46 offset:3784
    s_waitcnt vmcnt(10)
    v_or3_b32 v36, v104, v105, v106
    v_or3_b32 v36, v36, v107, v108
    v_or3_b32 v36, v36, v109, v110
    v_bitop3_b32 v36, v36, v111, 1 bitop3:0xa8
    v_cmp_ne_u32 vcc, 0, v36
    s_cbranch_vccnz L_u_retry
L_u_ok:
    ds_write_b128 v9, v[104:107] offset:0
    v_alignbit_b32 v36, v105, v104, 16
    v_alignbit_b32 v37, v106, v105, 16
    v_alignbit_b32 v38, v107, v106, 16
    ds_write_b16_d16_hi v9, v107 offset:140
    ds_write_b16 v10, v104 offset:0
    ds_write_b96 v9, v[36:38] offset:128
    ds_write_b128 v9, v[108:111] offset:12288
    v_alignbit_b32 v40, v109, v108, 16
    v_alignbit_b32 v41, v110, v109, 16
    v_alignbit_b32 v42, v111, v110, 16
    ds_write_b16_d16_hi v9, v111 offset:12428
    ds_write_b16 v10, v108 offset:12288
    ds_write_b96 v9, v[40:42] offset:12416
    s_lshl_b32 s62, s49, 16
    s_and_b32 s63, s49, 0xffff0000
    s_waitcnt lgkmcnt(0)
    s_barrier
    ds_read_b128 a[224:227], v16 offset:0
    ds_read_b128 a[228:231], v16 offset:1024
    ds_read_b128 a[232:235], v16 offset:2048
    ds_read_b128 a[236:239], v16 offset:3072
    s_waitcnt lgkmcnt(3)
    v_mfma_f32_16x16x32_bf16 v[32:35], v[128:131], a[224:227], 0
    ds_read_b128 a[240:243], v16 offset:4096
    v_mfma_f32_16x16x32_bf16 v[36:39], v[144:147], a[224:227], 0
    s_waitcnt lgkmcnt(3)
    v_mfma_f32_16x16x32_bf16 v[36:39], v[128:131], a[228:231], v[36:39]
    s_mov_b64 exec, 1
    buffer_store_dwordx2 v[124:125], v14, s[4:7], 0 offen sc1
    s_mov_b64 exec, -1
    ds_read_b128 a[244:247], v16 offset:5120
    v_mfma_f32_16x16x32_bf16 v[40:43], v[160:163], a[224:227], 0
    v_mfma_f32_16x16x32_bf16 v[40:43], v[144:147], a[228:231], v[40:43]
    ds_read_b128 a[248:251], v16 offset:6144
    s_waitcnt lgkmcnt(4)
    v_mfma_f32_16x16x32_bf16 v[40:43], v[128:131], a[232:235], v[40:43]
    v_mfma_f32_16x16x32_bf16 v[44:47], v[176:179], a[224:227], 0
    ds_read_b128 a[252:255], v16 offset:7168
    ds_read_b128 v[80:83], v25 offset:0
    v_mfma_f32_16x16x32_bf16 v[44:47], v[160:163], a[228:231], v[44:47]
    s_mov_b32 s66, 6291456
    ds_read_b128 v[84:87], v25 offset:12288
    v_mfma_f32_16x16x32_bf16 v[44:47], v[144:147], a[232:235], v[44:47]
    s_waitcnt lgkmcnt(6)
    v_mfma_f32_16x16x32_bf16 v[44:47], v[128:131], a[236:239], v[44:47]
    buffer_store_dwordx4 v[120:123], v28, s[4:7], s66 offen sc1
    v_mfma_f32_16x16x32_bf16 v[48:51], v[192:195], a[224:227], 0
    v_mfma_f32_16x16x32_bf16 v[48:51], v[176:179], a[228:231], v[48:51]
    v_mfma_f32_16x16x32_bf16 v[48:51], v[160:163], a[232:235], v[48:51]
    s_waitcnt lgkmcnt(0)
    v_lshlrev_b32 v64, 16, v83
    v_mfma_f32_16x16x32_bf16 v[48:51], v[144:147], a[236:239], v[48:51]
    v_lshlrev_b32 v65, 16, v82
    v_lshlrev_b32 v66, 16, v81
    v_mfma_f32_16x16x32_bf16 v[48:51], v[128:131], a[240:243], v[48:51]
    v_mfma_f32_16x16x32_bf16 v[52:55], v[208:211], a[224:227], 0
    v_lshlrev_b32 v67, 16, v80
    v_mfma_f32_16x16x32_bf16 v[52:55], v[192:195], a[228:231], v[52:55]
    buffer_store_dwordx4 v[120:123], v29, s[4:7], s66 offen sc1
    v_mfma_f32_16x16x32_bf16 v[52:55], v[176:179], a[232:235], v[52:55]
    v_lshlrev_b32 v68, 16, v87
    v_mfma_f32_16x16x32_bf16 v[52:55], v[160:163], a[236:239], v[52:55]
    v_mfma_f32_16x16x32_bf16 v[52:55], v[144:147], a[240:243], v[52:55]
    v_lshlrev_b32 v69, 16, v86
    v_mfma_f32_16x16x32_bf16 v[52:55], v[128:131], a[244:247], v[52:55]
    v_mfma_f32_16x16x32_bf16 v[56:59], v[224:227], a[224:227], 0
    s_add_u32 m0, s60, 65536
    s_add_u32 s59, s0, 458752
    v_mfma_f32_16x16x32_bf16 v[56:59], v[208:211], a[228:231], v[56:59]
    buffer_load_dwordx4 v20, s[28:31], s59 offen lds
    v_mfma_f32_16x16x32_bf16 v[56:59], v[192:195], a[232:235], v[56:59]
    v_lshlrev_b32 v70, 16, v85
    v_lshlrev_b32 v71, 16, v84
    v_mfma_f32_16x16x32_bf16 v[56:59], v[176:179], a[236:239], v[56:59]
    v_mul_f32 v64, s62, v64
    v_mfma_f32_16x16x32_bf16 v[56:59], v[160:163], a[240:243], v[56:59]
    v_mfma_f32_16x16x32_bf16 v[56:59], v[144:147], a[244:247], v[56:59]
    v_mul_f32 v65, s62, v65
    v_mfma_f32_16x16x32_bf16 v[56:59], v[128:131], a[248:251], v[56:59]
    v_mfma_f32_16x16x32_bf16 v[60:63], v[240:243], a[224:227], 0
    ds_read_b128 a[224:227], v17 offset:0
    v_mul_f32 v66, s62, v66
    v_mfma_f32_16x16x32_bf16 v[60:63], v[224:227], a[228:231], v[60:63]
    ds_read_b128 a[228:231], v17 offset:1024
    v_mfma_f32_16x16x32_bf16 v[60:63], v[208:211], a[232:235], v[60:63]
    buffer_load_dwordx4 v20, s[32:35], s59 offen offset:1024 lds
    ds_read_b128 a[232:235], v17 offset:2048
    v_mfma_f32_16x16x32_bf16 v[60:63], v[192:195], a[236:239], v[60:63]
    ds_read_b128 a[236:239], v17 offset:3072
    v_mul_f32 v67, s62, v67
    v_mfma_f32_16x16x32_bf16 v[60:63], v[176:179], a[240:243], v[60:63]
    v_mul_f32 v68, s63, v68
    v_mfma_f32_16x16x32_bf16 v[60:63], v[160:163], a[244:247], v[60:63]
    v_mfma_f32_16x16x32_bf16 v[60:63], v[144:147], a[248:251], v[60:63]
    v_mul_f32 v69, s63, v69
    v_mfma_f32_16x16x32_bf16 v[60:63], v[128:131], a[252:255], v[60:63]
    s_add_u32 m0, s60, 73728
    s_waitcnt lgkmcnt(3)
    v_mfma_f32_16x16x32_bf16 v[32:35], v[132:135], a[224:227], v[32:35]
    s_add_u32 s59, s0, 516096
    v_mul_f32 v70, s63, v70
    v_mfma_f32_16x16x32_bf16 v[36:39], v[148:151], a[224:227], v[36:39]
    ds_read_b128 a[240:243], v17 offset:4096
    s_waitcnt lgkmcnt(3)
    v_mfma_f32_16x16x32_bf16 v[36:39], v[132:135], a[228:231], v[36:39]
    buffer_load_dwordx4 v20, s[28:31], s59 offen lds
    v_mfma_f32_16x16x32_bf16 v[40:43], v[164:167], a[224:227], v[40:43]
    ds_read_b128 a[244:247], v17 offset:5120
    v_mul_f32 v71, s63, v71
    v_mfma_f32_16x16x32_bf16 v[40:43], v[148:151], a[228:231], v[40:43]
    s_waitcnt lgkmcnt(3)
    v_mfma_f32_16x16x32_bf16 v[40:43], v[132:135], a[232:235], v[40:43]
    ds_read_b128 a[248:251], v17 offset:6144
    v_mfma_f32_16x16x32_bf16 v[44:47], v[180:183], a[224:227], v[44:47]
    v_mfma_f32_16x16x32_bf16 v[44:47], v[164:167], a[228:231], v[44:47]
    ds_read_b128 a[252:255], v17 offset:7168
    v_mfma_f32_16x16x32_bf16 v[44:47], v[148:151], a[232:235], v[44:47]
    buffer_load_dwordx4 v20, s[32:35], s59 offen offset:1024 lds
    s_waitcnt lgkmcnt(4)
    v_mfma_f32_16x16x32_bf16 v[44:47], v[132:135], a[236:239], v[44:47]
    v_mfma_f32_16x16x32_bf16 v[48:51], v[196:199], a[224:227], v[48:51]
    v_mfma_f32_16x16x32_bf16 v[48:51], v[180:183], a[228:231], v[48:51]
    v_mfma_f32_16x16x32_bf16 v[48:51], v[164:167], a[232:235], v[48:51]
    v_mfma_f32_16x16x32_bf16 v[48:51], v[148:151], a[236:239], v[48:51]
    s_add_u32 m0, s60, 81920
    s_waitcnt lgkmcnt(3)
    v_mfma_f32_16x16x32_bf16 v[48:51], v[132:135], a[240:243], v[48:51]
    s_add_u32 s59, s0, 573440
    v_mfma_f32_16x16x32_bf16 v[52:55], v[212:215], a[224:227], v[52:55]
    buffer_load_dwordx4 v20, s[28:31], s59 offen lds
    v_mfma_f32_16x16x32_bf16 v[52:55], v[196:199], a[228:231], v[52:55]
    v_mfma_f32_16x16x32_bf16 v[52:55], v[180:183], a[232:235], v[52:55]
    v_mfma_f32_16x16x32_bf16 v[52:55], v[164:167], a[236:239], v[52:55]
    v_mfma_f32_16x16x32_bf16 v[52:55], v[148:151], a[240:243], v[52:55]
    s_waitcnt lgkmcnt(2)
    v_mfma_f32_16x16x32_bf16 v[52:55], v[132:135], a[244:247], v[52:55]
    v_mfma_f32_16x16x32_bf16 v[56:59], v[228:231], a[224:227], v[56:59]
    buffer_load_dwordx4 v20, s[32:35], s59 offen offset:1024 lds
    v_mfma_f32_16x16x32_bf16 v[56:59], v[212:215], a[228:231], v[56:59]
    v_mfma_f32_16x16x32_bf16 v[56:59], v[196:199], a[232:235], v[56:59]
    v_mfma_f32_16x16x32_bf16 v[56:59], v[180:183], a[236:239], v[56:59]
    v_mfma_f32_16x16x32_bf16 v[56:59], v[164:167], a[240:243], v[56:59]
    v_mfma_f32_16x16x32_bf16 v[56:59], v[148:151], a[244:247], v[56:59]
    s_waitcnt lgkmcnt(1)
    v_mfma_f32_16x16x32_bf16 v[56:59], v[132:135], a[248:251], v[56:59]
    s_add_u32 m0, s60, 90112
    s_add_u32 s59, s0, 630784
    v_mfma_f32_16x16x32_bf16 v[60:63], v[244:247], a[224:227], v[60:63]
    ds_read_b128 a[224:227], v18 offset:0
    v_mfma_f32_16x16x32_bf16 v[60:63], v[228:231], a[228:231], v[60:63]
    buffer_load_dwordx4 v20, s[28:31], s59 offen lds
    ds_read_b128 a[228:231], v18 offset:1024
    v_mfma_f32_16x16x32_bf16 v[60:63], v[212:215], a[232:235], v[60:63]
    ds_read_b128 a[232:235], v18 offset:2048
    v_mfma_f32_16x16x32_bf16 v[60:63], v[196:199], a[236:239], v[60:63]
    ds_read_b128 a[236:239], v18 offset:3072
    v_mfma_f32_16x16x32_bf16 v[60:63], v[180:183], a[240:243], v[60:63]
    v_mfma_f32_16x16x32_bf16 v[60:63], v[164:167], a[244:247], v[60:63]
    v_mfma_f32_16x16x32_bf16 v[60:63], v[148:151], a[248:251], v[60:63]
    s_waitcnt vmcnt(10)
    s_waitcnt lgkmcnt(4)
    v_mfma_f32_16x16x32_bf16 v[60:63], v[132:135], a[252:255], v[60:63]
    s_barrier
    s_waitcnt lgkmcnt(3)
    v_mfma_f32_16x16x32_bf16 v[32:35], v[136:139], a[224:227], v[32:35]
    buffer_load_dwordx4 v20, s[32:35], s59 offen offset:1024 lds
    v_mfma_f32_16x16x32_bf16 v[36:39], v[152:155], a[224:227], v[36:39]
    ds_read_b128 a[240:243], v18 offset:4096
    s_waitcnt lgkmcnt(3)
    v_mfma_f32_16x16x32_bf16 v[36:39], v[136:139], a[228:231], v[36:39]
    ds_read_b64_tr_b16 a[0:1], v21 offset:0
    ds_read_b64_tr_b16 a[2:3], v21 offset:2048
    v_mfma_f32_16x16x32_bf16 v[40:43], v[168:171], a[224:227], v[40:43]
    ds_read_b128 a[244:247], v18 offset:5120
    ds_read_b64_tr_b16 a[4:5], v22 offset:0
    v_mfma_f32_16x16x32_bf16 v[40:43], v[152:155], a[228:231], v[40:43]
    ds_read_b64_tr_b16 a[6:7], v22 offset:2048
    s_waitcnt lgkmcnt(7)
    v_mfma_f32_16x16x32_bf16 v[40:43], v[136:139], a[232:235], v[40:43]
    ds_read_b128 a[248:251], v18 offset:6144
    s_add_u32 m0, s60, 98304
    v_mfma_f32_16x16x32_bf16 v[44:47], v[184:187], a[224:227], v[44:47]
    s_add_u32 s59, s0, 688128
    ds_read_b64_tr_b16 a[8:9], v21 offset:1024
    v_mfma_f32_16x16x32_bf16 v[44:47], v[168:171], a[228:231], v[44:47]
    ds_read_b128 a[252:255], v18 offset:7168
    ds_read_b64_tr_b16 a[10:11], v21 offset:3072
    v_mfma_f32_16x16x32_bf16 v[44:47], v[152:155], a[232:235], v[44:47]
    buffer_load_dwordx4 v20, s[28:31], s59 offen lds
    s_waitcnt lgkmcnt(10)
    v_mfma_f32_16x16x32_bf16 v[44:47], v[136:139], a[236:239], v[44:47]
    ds_read_b64_tr_b16 a[12:13], v22 offset:1024
    ds_read_b64_tr_b16 a[14:15], v22 offset:3072
    v_mfma_f32_16x16x32_bf16 v[48:51], v[200:203], a[224:227], v[48:51]
    ds_read_b64_tr_b16 a[16:17], v21 offset:16384
    ds_read_b64_tr_b16 a[18:19], v21 offset:18432
    v_mfma_f32_16x16x32_bf16 v[48:51], v[184:187], a[228:231], v[48:51]
    ds_read_b64_tr_b16 a[20:21], v22 offset:16384
    ds_read_b64_tr_b16 a[22:23], v22 offset:18432
    v_mfma_f32_16x16x32_bf16 v[48:51], v[168:171], a[232:235], v[48:51]
    ds_read_b64_tr_b16 a[24:25], v21 offset:17408
    v_mfma_f32_16x16x32_bf16 v[48:51], v[152:155], a[236:239], v[48:51]
    ds_read_b64_tr_b16 a[26:27], v21 offset:19456
    s_waitcnt lgkmcnt(15)
    v_mfma_f32_16x16x32_bf16 v[48:51], v[136:139], a[240:243], v[48:51]
    buffer_load_dwordx4 v20, s[32:35], s59 offen offset:1024 lds
    v_mfma_f32_16x16x32_bf16 v[52:55], v[216:219], a[224:227], v[52:55]
    ds_read_b64_tr_b16 a[28:29], v22 offset:17408
    ds_read_b64_tr_b16 a[30:31], v22 offset:19456
    v_mfma_f32_16x16x32_bf16 v[52:55], v[200:203], a[228:231], v[52:55]
    ds_read_b64_tr_b16 a[32:33], v21 offset:32768
    v_mfma_f32_16x16x32_bf16 v[52:55], v[184:187], a[232:235], v[52:55]
    ds_read_b64_tr_b16 a[34:35], v21 offset:34816
    v_mfma_f32_16x16x32_bf16 v[52:55], v[168:171], a[236:239], v[52:55]
    ds_read_b64_tr_b16 a[36:37], v22 offset:32768
    v_mfma_f32_16x16x32_bf16 v[52:55], v[152:155], a[240:243], v[52:55]
    s_add_u32 m0, s60, 106496
    s_waitcnt lgkmcnt(15)
    v_mfma_f32_16x16x32_bf16 v[52:55], v[136:139], a[244:247], v[52:55]
    s_add_u32 s59, s0, 745472
    ds_read_b64_tr_b16 a[38:39], v22 offset:34816
    v_mfma_f32_16x16x32_bf16 v[56:59], v[232:235], a[224:227], v[56:59]
    buffer_load_dwordx4 v20, s[28:31], s59 offen lds
    v_mfma_f32_16x16x32_bf16 v[56:59], v[216:219], a[228:231], v[56:59]
    ds_read_b64_tr_b16 a[40:41], v21 offset:33792
    ds_read_b64_tr_b16 a[42:43], v21 offset:35840
    v_mfma_f32_16x16x32_bf16 v[56:59], v[200:203], a[232:235], v[56:59]
    ds_read_b64_tr_b16 a[44:45], v22 offset:33792
    v_mfma_f32_16x16x32_bf16 v[56:59], v[184:187], a[236:239], v[56:59]
    ds_read_b64_tr_b16 a[46:47], v22 offset:35840
    v_mfma_f32_16x16x32_bf16 v[56:59], v[168:171], a[240:243], v[56:59]
    ds_read_b64_tr_b16 a[48:49], v21 offset:49152
    v_mfma_f32_16x16x32_bf16 v[56:59], v[152:155], a[244:247], v[56:59]
    ds_read_b64_tr_b16 a[50:51], v21 offset:51200
    v_mfma_f32_16x16x32_bf16 v[56:59], v[136:139], a[248:251], v[56:59]
    buffer_load_dwordx4 v20, s[32:35], s59 offen offset:1024 lds
    v_mfma_f32_16x16x32_bf16 v[60:63], v[248:251], a[224:227], v[60:63]
    ds_read_b128 a[224:227], v19 offset:0
    ds_read_b64_tr_b16 a[52:53], v22 offset:49152
    v_mfma_f32_16x16x32_bf16 v[60:63], v[232:235], a[228:231], v[60:63]
    ds_read_b128 a[228:231], v19 offset:1024
    ds_read_b64_tr_b16 a[54:55], v22 offset:51200
    v_mfma_f32_16x16x32_bf16 v[60:63], v[216:219], a[232:235], v[60:63]
    ds_read_b128 a[232:235], v19 offset:2048
    ds_read_b64_tr_b16 a[56:57], v21 offset:50176
    v_mfma_f32_16x16x32_bf16 v[60:63], v[200:203], a[236:239], v[60:63]
    ds_read_b128 a[236:239], v19 offset:3072
    ds_read_b64_tr_b16 a[58:59], v21 offset:52224
    v_mfma_f32_16x16x32_bf16 v[60:63], v[184:187], a[240:243], v[60:63]
    ds_read_b64_tr_b16 a[60:61], v22 offset:50176
    ds_read_b64_tr_b16 a[62:63], v22 offset:52224
    v_mfma_f32_16x16x32_bf16 v[60:63], v[168:171], a[244:247], v[60:63]
    v_mfma_f32_16x16x32_bf16 v[60:63], v[152:155], a[248:251], v[60:63]
    s_waitcnt lgkmcnt(15)
    v_mfma_f32_16x16x32_bf16 v[60:63], v[136:139], a[252:255], v[60:63]
    s_waitcnt lgkmcnt(9)
    v_mfma_f32_16x16x32_bf16 v[32:35], v[140:143], a[224:227], v[32:35]
    v_mfma_f32_16x16x32_bf16 v[36:39], v[156:159], a[224:227], v[36:39]
    ds_read_b128 a[240:243], v19 offset:4096
    s_waitcnt lgkmcnt(8)
    v_mfma_f32_16x16x32_bf16 v[36:39], v[140:143], a[228:231], v[36:39]
    v_mfma_f32_16x16x32_bf16 v[40:43], v[172:175], a[224:227], v[40:43]
    ds_read_b128 a[244:247], v19 offset:5120
    ds_read_b128 v[80:83], v25 offset:4096
    v_mfma_f32_16x16x32_bf16 v[40:43], v[156:159], a[228:231], v[40:43]
    ds_read_b128 v[84:87], v25 offset:16384
    s_waitcnt lgkmcnt(9)
    v_mfma_f32_16x16x32_bf16 v[40:43], v[140:143], a[232:235], v[40:43]
    ds_read_b128 a[248:251], v19 offset:6144
    v_mfma_f32_16x16x32_bf16 v[44:47], v[188:191], a[224:227], v[44:47]
    ds_write_b128 v3, v[32:35] offset:0
    v_mfma_f32_16x16x32_bf16 v[44:47], v[172:175], a[228:231], v[44:47]
    ds_read_b128 a[252:255], v19 offset:7168
    v_mfma_f32_16x16x32_bf16 v[44:47], v[156:159], a[232:235], v[44:47]
    s_waitcnt lgkmcnt(10)
    v_mfma_f32_16x16x32_bf16 v[44:47], v[140:143], a[236:239], v[44:47]
    s_waitcnt lgkmcnt(3)
    v_lshlrev_b32 v72, 16, v83
    v_mfma_f32_16x16x32_bf16 v[48:51], v[204:207], a[224:227], v[48:51]
    ds_write_b128 v3, v[36:39] offset:4096
    v_mfma_f32_16x16x32_bf16 v[48:51], v[188:191], a[228:231], v[48:51]
    v_lshlrev_b32 v73, 16, v82
    v_lshlrev_b32 v74, 16, v81
    v_mfma_f32_16x16x32_bf16 v[48:51], v[172:175], a[232:235], v[48:51]
    v_lshlrev_b32 v75, 16, v80
    v_lshlrev_b32 v76, 16, v87
    v_mfma_f32_16x16x32_bf16 v[48:51], v[156:159], a[236:239], v[48:51]
    v_lshlrev_b32 v77, 16, v86
    v_lshlrev_b32 v78, 16, v85
    v_mfma_f32_16x16x32_bf16 v[48:51], v[140:143], a[240:243], v[48:51]
    ds_write_b128 v3, v[40:43] offset:8192
    v_mfma_f32_16x16x32_bf16 v[52:55], v[220:223], a[224:227], v[52:55]
    v_lshlrev_b32 v79, 16, v84
    v_mul_f32 v72, s62, v72
    v_mfma_f32_16x16x32_bf16 v[52:55], v[204:207], a[228:231], v[52:55]
    v_mul_f32 v73, s62, v73
    v_mul_f32 v74, s62, v74
    v_mfma_f32_16x16x32_bf16 v[52:55], v[188:191], a[232:235], v[52:55]
    v_mul_f32 v75, s62, v75
    v_mul_f32 v76, s63, v76
    v_mfma_f32_16x16x32_bf16 v[52:55], v[172:175], a[236:239], v[52:55]
    ds_write_b128 v3, v[44:47] offset:12288
    v_mfma_f32_16x16x32_bf16 v[52:55], v[156:159], a[240:243], v[52:55]
    v_mul_f32 v77, s63, v77
    v_mul_f32 v78, s63, v78
    v_mfma_f32_16x16x32_bf16 v[52:55], v[140:143], a[244:247], v[52:55]
    v_mul_f32 v79, s63, v79
    v_mfma_f32_16x16x32_bf16 v[56:59], v[236:239], a[224:227], v[56:59]
    v_mfma_f32_16x16x32_bf16 v[56:59], v[220:223], a[228:231], v[56:59]
    ds_write_b128 v3, v[48:51] offset:16384
    v_mfma_f32_16x16x32_bf16 v[56:59], v[204:207], a[232:235], v[56:59]
    v_mfma_f32_16x16x32_bf16 v[56:59], v[188:191], a[236:239], v[56:59]
    v_mfma_f32_16x16x32_bf16 v[56:59], v[172:175], a[240:243], v[56:59]
    v_mfma_f32_16x16x32_bf16 v[56:59], v[156:159], a[244:247], v[56:59]
    s_waitcnt lgkmcnt(6)
    v_mfma_f32_16x16x32_bf16 v[56:59], v[140:143], a[248:251], v[56:59]
    v_mfma_f32_16x16x32_bf16 v[60:63], v[252:255], a[224:227], v[60:63]
    ds_write_b128 v3, v[52:55] offset:20480
    v_mfma_f32_16x16x32_bf16 v[60:63], v[236:239], a[228:231], v[60:63]
    s_barrier
    v_mfma_f32_16x16x32_bf16 v[60:63], v[220:223], a[232:235], v[60:63]
    v_mfma_f32_16x16x32_bf16 v[60:63], v[204:207], a[236:239], v[60:63]
    v_mfma_f32_16x16x32_bf16 v[60:63], v[188:191], a[240:243], v[60:63]
    v_mfma_f32_16x16x32_bf16 v[60:63], v[172:175], a[244:247], v[60:63]
    v_mfma_f32_16x16x32_bf16 v[60:63], v[156:159], a[248:251], v[60:63]
    s_waitcnt lgkmcnt(5)
    v_mfma_f32_16x16x32_bf16 v[60:63], v[140:143], a[252:255], v[60:63]
    ds_write_b128 v3, v[56:59] offset:24576
    s_nop 6
    ds_write_b128 v3, v[60:63] offset:36864
    v_lshlrev_b32 v14, 5, v0
    v_add_u32 v14, 393216, v14
    s_waitcnt vmcnt(12)
    s_waitcnt lgkmcnt(0)
    s_barrier
    ds_read_b128 v[128:131], v2 offset:0
    ds_read_b128 v[132:135], v2 offset:1024
    ds_read_b128 v[136:139], v2 offset:2048
    ds_read_b128 v[140:143], v2 offset:3072
    ds_read_b128 v[144:147], v31 offset:0
    ds_read_b128 v[148:151], v31 offset:1024
    ds_read_b128 v[152:155], v31 offset:2048
    ds_read_b128 v[156:159], v31 offset:3072
    buffer_load_dwordx2 v[126:127], v14, s[4:7], 0 offen sc1
    s_waitcnt lgkmcnt(7)
    v_pk_add_f32 v[64:65], v[64:65], v[128:129]
    v_pk_add_f32 v[66:67], v[66:67], v[130:131]
    s_waitcnt lgkmcnt(6)
    v_pk_add_f32 v[64:65], v[64:65], v[132:133]
    v_pk_add_f32 v[66:67], v[66:67], v[134:135]
    s_waitcnt lgkmcnt(5)
    v_pk_add_f32 v[68:69], v[68:69], v[136:137]
    v_pk_add_f32 v[70:71], v[70:71], v[138:139]
    s_waitcnt lgkmcnt(4)
    v_pk_add_f32 v[68:69], v[68:69], v[140:141]
    v_pk_add_f32 v[70:71], v[70:71], v[142:143]
    v_cvt_pk_bf16_f32 v96, v64, v68
    v_cvt_pk_bf16_f32 v97, v65, v69
    v_cvt_pk_bf16_f32 v98, v66, v70
    v_cvt_pk_bf16_f32 v99, v67, v71
    v_or_b32 v96, 1, v96
    v_or_b32 v97, 1, v97
    v_or_b32 v98, 1, v98
    v_or_b32 v99, 1, v99
    buffer_store_dwordx4 v[96:99], v12, s[4:7], 0 offen sc1
    s_waitcnt lgkmcnt(3)
    v_pk_add_f32 v[72:73], v[72:73], v[144:145]
    v_pk_add_f32 v[74:75], v[74:75], v[146:147]
    s_waitcnt lgkmcnt(2)
    v_pk_add_f32 v[72:73], v[72:73], v[148:149]
    v_pk_add_f32 v[74:75], v[74:75], v[150:151]
    s_waitcnt lgkmcnt(1)
    v_pk_add_f32 v[76:77], v[76:77], v[152:153]
    v_pk_add_f32 v[78:79], v[78:79], v[154:155]
    s_waitcnt lgkmcnt(0)
    v_pk_add_f32 v[76:77], v[76:77], v[156:157]
    v_pk_add_f32 v[78:79], v[78:79], v[158:159]
    v_cvt_pk_bf16_f32 v100, v72, v76
    v_cvt_pk_bf16_f32 v101, v73, v77
    v_cvt_pk_bf16_f32 v102, v74, v78
    v_cvt_pk_bf16_f32 v103, v75, v79
    v_or_b32 v100, 1, v100
    v_or_b32 v101, 1, v101
    v_or_b32 v102, 1, v102
    v_or_b32 v103, 1, v103
    buffer_store_dwordx4 v[100:103], v13, s[4:7], 0 offen sc1
    s_add_u32 m0, s60, 0
    s_add_u32 s59, s1, 0
    buffer_load_dwordx4 v20, s[28:31], s59 offen lds
    buffer_load_dwordx4 v20, s[32:35], s59 offen offset:1024 lds
    s_add_u32 m0, s60, 8192
    s_add_u32 s59, s1, 57344
    buffer_load_dwordx4 v20, s[28:31], s59 offen lds
    buffer_load_dwordx4 v20, s[32:35], s59 offen offset:1024 lds
    s_add_u32 m0, s60, 16384
    s_add_u32 s59, s1, 114688
    buffer_load_dwordx4 v20, s[28:31], s59 offen lds
    buffer_load_dwordx4 v20, s[32:35], s59 offen offset:1024 lds
    s_add_u32 m0, s60, 24576
    s_add_u32 s59, s1, 172032
    buffer_load_dwordx4 v20, s[28:31], s59 offen lds
    buffer_load_dwordx4 v20, s[32:35], s59 offen offset:1024 lds
    s_add_u32 m0, s60, 32768
    s_add_u32 s59, s1, 229376
    buffer_load_dwordx4 v20, s[28:31], s59 offen lds
    buffer_load_dwordx4 v20, s[32:35], s59 offen offset:1024 lds
    s_add_u32 m0, s60, 40960
    s_add_u32 s59, s1, 286720
    buffer_load_dwordx4 v20, s[28:31], s59 offen lds
    buffer_load_dwordx4 v20, s[32:35], s59 offen offset:1024 lds
L_pg2:
    s_cbranch_execz L_warm
    s_add_u32 m0, s60, 49152
    s_add_u32 s59, s1, 344064
    buffer_load_dwordx4 v20, s[28:31], s59 offen lds
    buffer_load_dwordx4 v20, s[32:35], s59 offen offset:1024 lds
    s_add_u32 m0, s60, 57344
    s_add_u32 s59, s1, 401408
    buffer_load_dwordx4 v20, s[28:31], s59 offen lds
    buffer_load_dwordx4 v20, s[32:35], s59 offen offset:1024 lds
L_stageB:
    v_lshrrev_b32 v4, 1, v1
    v_min_u32 v4, 27, v4
    v_and_b32 v5, 1, v1
    s_mul_i32 s57, s3, 56
    v_add_u32 v4, s57, v4
    v_mul_u32_u24 v13, 9216, v4
    v_lshl_add_u32 v13, v5, 4, v13
    s_lshl_b32 s62, s52, 10
    s_lshl_b32 s58, s53, 5
    s_add_u32 s62, s62, s58
    s_and_b32 s58, s52, 4
    s_lshl_b32 s58, s58, 7
    s_add_u32 s62, s62, s58
    s_add_u32 s62, s62, 2097152
    s_add_u32 s63, s62, 258048
    v_lshrrev_b32 v10, 5, v1
    v_bfe_u32 v9, v1, 2, 3
    v_mul_u32_u24 v3, 896, v9
    v_lshl_add_u32 v3, v10, 6, v3
    v_and_b32 v9, 3, v1
    v_lshl_add_u32 v3, v9, 4, v3
    s_mul_i32 s58, s3, 401408
    s_lshl_b32 s47, s14, 7
    s_add_u32 s58, s58, s47
    s_cmp_ge_u32 s53, 28
    s_cselect_b32 s58, 0x80000000, s58
    v_add_u32 v3, s58, v3
    s_mul_i32 s64, s3, 12288
    s_add_u32 s64, s64, 114688
    s_mul_i32 s16, s3, 14336
    s_add_u32 s16, s16, 57344
    v_bfe_u32 v23, v1, 2, 3
    v_lshlrev_b32 v23, 6, v23
    v_lshl_add_u32 v23, v9, 3, v23
    v_lshl_add_u32 v23, v10, 10, v23
    v_add_u32 v23, s64, v23
    s_sub_u32 s58, s16, s64
    v_add_u32 v0, s58, v23
    s_lshr_b32 s10, s15, 10
    s_add_u32 s10, s10, s14
    s_and_b32 s10, s10, 0
    s_mul_i32 s8, s10, 200704
    s_sub_u32 s9, 200704, s8
    s_waitcnt vmcnt(18)
    v_cmp_ne_u64 vcc, s[50:51], v[126:127]
    s_cbranch_vccz L_fb_ok
    s_mov_b32 s67, 0
L_fb_loop:
    buffer_load_dwordx2 v[126:127], v14, s[4:7], 0 offen sc1
    s_waitcnt vmcnt(0) lgkmcnt(0)
    v_cmp_ne_u64 vcc, s[50:51], v[126:127]
    s_cbranch_vccz L_fb_ok
    s_add_u32 s67, s67, 1
    s_cmp_lt_u32 s67, 65536
    s_cbranch_scc1 L_fb_loop
L_fb_ok:
    s_mul_i32 s57, s3, 3072
    s_lshl_b32 s58, s57, 2
    s_add_u32 m0, s58, 123904
    s_add_u32 s57, s57, 49152
    s_waitcnt lgkmcnt(0)
    s_barrier
    buffer_load_dwordx4 v11, s[4:7], s57 offen offset:0 sc1 lds
    buffer_load_dwordx4 v11, s[4:7], s57 offen offset:1024 sc1 lds
    buffer_load_dwordx4 v11, s[4:7], s57 offen offset:2048 sc1 lds
    buffer_load_dwordx4 v[104:107], v13, s[4:7], s62 offen sc1
    buffer_load_dwordx4 v[108:111], v13, s[4:7], s63 offen sc1
    v_xor_b32 v21, 65536, v21
    s_add_u32 m0, s64, 0
    s_add_u32 s58, s8, 0
    buffer_load_dwordx4 v3, s[36:39], s58 offen lds
    v_xor_b32 v22, 65536, v22
    ds_read_b64_tr_b16 a[64:65], v21 offset:0
    ds_read_b64_tr_b16 a[66:67], v21 offset:2048
    ds_read_b64_tr_b16 a[68:69], v22 offset:0
    ds_read_b64_tr_b16 a[70:71], v22 offset:2048
    ds_read_b64_tr_b16 a[72:73], v21 offset:1024
    ds_read_b64_tr_b16 a[74:75], v21 offset:3072
    ds_read_b64_tr_b16 a[76:77], v22 offset:1024
    ds_read_b64_tr_b16 a[78:79], v22 offset:3072
    ds_read_b64_tr_b16 a[80:81], v21 offset:16384
    ds_read_b64_tr_b16 a[82:83], v21 offset:18432
    s_add_u32 m0, s64, 1024
    s_add_u32 s58, s8, 7168
    buffer_load_dwordx4 v3, s[36:39], s58 offen lds
    ds_read_b64_tr_b16 a[84:85], v22 offset:16384
    ds_read_b64_tr_b16 a[86:87], v22 offset:18432
    ds_read_b64_tr_b16 a[88:89], v21 offset:17408
    ds_read_b64_tr_b16 a[90:91], v21 offset:19456
    ds_read_b64_tr_b16 a[92:93], v22 offset:17408
    ds_read_b64_tr_b16 a[94:95], v22 offset:19456
    ds_read_b64_tr_b16 a[96:97], v21 offset:32768
    ds_read_b64_tr_b16 a[98:99], v21 offset:34816
    ds_read_b64_tr_b16 a[100:101], v22 offset:32768
    ds_read_b64_tr_b16 a[102:103], v22 offset:34816
    ds_read_b64_tr_b16 a[104:105], v21 offset:33792
    ds_read_b64_tr_b16 a[106:107], v21 offset:35840
    s_add_u32 m0, s64, 2048
    s_add_u32 s58, s8, 14336
    buffer_load_dwordx4 v3, s[36:39], s58 offen lds
    ds_read_b64_tr_b16 a[108:109], v22 offset:33792
    ds_read_b64_tr_b16 a[110:111], v22 offset:35840
    v_lshlrev_b32 v32, 16, v112
    v_and_b32 v33, 0xffff0000, v112
    v_lshlrev_b32 v34, 16, v113
    v_and_b32 v35, 0xffff0000, v113
    v_lshlrev_b32 v36, 16, v114
    v_and_b32 v37, 0xffff0000, v114
    v_lshlrev_b32 v38, 16, v115
    v_and_b32 v39, 0xffff0000, v115
    v_lshlrev_b32 v40, 16, v116
    v_and_b32 v41, 0xffff0000, v116
    s_add_u32 m0, s64, 3072
    s_add_u32 s58, s8, 21504
    buffer_load_dwordx4 v3, s[36:39], s58 offen lds
    v_lshlrev_b32 v42, 16, v117
    v_and_b32 v43, 0xffff0000, v117
    v_lshlrev_b32 v44, 16, v118
    v_and_b32 v45, 0xffff0000, v118
    v_lshlrev_b32 v46, 16, v119
    v_and_b32 v47, 0xffff0000, v119
    v_pk_fma_f32 v[48:49], v[32:33], v[6:7], v[6:7] op_sel:[0,0,1] op_sel_hi:[1,0,1]
    v_pk_fma_f32 v[50:51], v[34:35], v[6:7], v[6:7] op_sel:[0,0,1] op_sel_hi:[1,0,1]
    v_pk_fma_f32 v[52:53], v[36:37], v[6:7], v[6:7] op_sel:[0,0,1] op_sel_hi:[1,0,1]
    v_pk_fma_f32 v[54:55], v[38:39], v[6:7], v[6:7] op_sel:[0,0,1] op_sel_hi:[1,0,1]
    v_pk_fma_f32 v[56:57], v[40:41], v[6:7], v[6:7] op_sel:[0,0,1] op_sel_hi:[1,0,1]
    v_pk_fma_f32 v[58:59], v[42:43], v[6:7], v[6:7] op_sel:[0,0,1] op_sel_hi:[1,0,1]
    v_pk_fma_f32 v[60:61], v[44:45], v[6:7], v[6:7] op_sel:[0,0,1] op_sel_hi:[1,0,1]
    v_pk_fma_f32 v[62:63], v[46:47], v[6:7], v[6:7] op_sel:[0,0,1] op_sel_hi:[1,0,1]
    v_min_u32 v25, 23, v24
    v_and_b32 v8, 24, v24
    v_add_lshl_u32 v8, v8, v24, 4
    v_and_b32 v9, 24, v25
    v_add_lshl_u32 v9, v9, v25, 4
    v_bfe_u32 v10, v1, 3, 1
    v_lshl_add_u32 v8, v10, 7, v8
    v_bfe_u32 v10, v25, 3, 1
    v_lshl_add_u32 v9, v10, 7, v9
    v_add_u32 v8, 123904, v8
    v_add_u32 v9, 123904, v9
    v_xor_b32 v100, 128, v8
    v_xor_b32 v101, 128, v9
    v_mul_u32_u24 v16, 24576, v5
    v_lshl_add_u32 v16, v4, 2, v16
    v_add_u32 v16, 121856, v16
    v_add_u32 v17, 12288, v16
    v_add_u32 v18, 112, v16
    v_add_u32 v19, 112, v17
    v_lshrrev_b32 v4, 5, v1
    v_mul_u32_u24 v4, 928, v4
    s_mul_i32 s57, s3, 12288
    s_add_u32 s57, s57, 121856
    v_add_u32 v4, s57, v4
    v_lshl_add_u32 v30, v24, 4, v4
    v_cmp_gt_u32 vcc, 24, v24
    v_lshl_add_u32 v31, v25, 4, v4
    v_add_u32 v31, 512, v31
    v_cndmask_b32 v12, 0, -1, vcc
    s_waitcnt vmcnt(4)
    v_bitop3_b32 v15, v104, v105, v106 bitop3:0x80
    v_bitop3_b32 v15, v15, v107, v108 bitop3:0x80
    v_bitop3_b32 v15, v15, v109, v110 bitop3:0x80
    v_bitop3_b32 v15, v15, v111, 1 bitop3:0x80
    v_cmp_eq_u32 vcc, 0, v15
    s_cbranch_vccnz L_yy_retry
L_yy_ok:
    ds_write2_b32 v16, v104, v105 offset0:0 offset1:232
    ds_write2_b32 v17, v106, v107 offset0:0 offset1:232
    ds_write2_b32 v18, v108, v109 offset0:0 offset1:232
    ds_write2_b32 v19, v110, v111 offset0:0 offset1:232
    s_waitcnt lgkmcnt(0)
    s_barrier
    ds_read_b128 v[104:107], v30
    ds_read_b128 v[108:111], v31
    ds_read_b128 v[168:171], v8 offset:0
    ds_read_b128 v[172:175], v100 offset:0
    ds_read_b128 v[176:179], v9 offset:1024
    ds_read_b128 v[180:183], v101 offset:1024
    ds_read_b128 v[188:191], v8 offset:2048
    ds_read_b128 v[184:187], v100 offset:2048
    ds_read_b128 v[196:199], v9 offset:12288
    ds_read_b128 v[192:195], v101 offset:12288
    ds_read_b128 v[200:203], v8 offset:13312
    ds_read_b128 v[204:207], v100 offset:13312
    ds_read_b128 v[208:211], v9 offset:14336
    ds_read_b128 v[212:215], v101 offset:14336
    s_add_u32 m0, s60, 65536
    s_add_u32 s59, s1, 458752
    buffer_load_dwordx4 v20, s[28:31], s59 offen lds
    s_waitcnt lgkmcnt(13)
    v_lshlrev_b32 v80, 16, v104
    v_and_b32 v81, 0xffff0000, v104
    v_lshlrev_b32 v82, 16, v105
    v_and_b32 v83, 0xffff0000, v105
    v_lshlrev_b32 v84, 16, v106
    v_and_b32 v85, 0xffff0000, v106
    v_lshlrev_b32 v86, 16, v107
    v_and_b32 v87, 0xffff0000, v107
    s_waitcnt lgkmcnt(12)
    v_and_b32 v108, v12, v108
    v_lshlrev_b32 v88, 16, v108
    v_and_b32 v89, 0xffff0000, v108
    v_and_b32 v109, v12, v109
    buffer_load_dwordx4 v20, s[32:35], s59 offen offset:1024 lds
    v_lshlrev_b32 v90, 16, v109
    v_and_b32 v91, 0xffff0000, v109
    v_and_b32 v110, v12, v110
    v_lshlrev_b32 v92, 16, v110
    v_and_b32 v93, 0xffff0000, v110
    v_and_b32 v111, v12, v111
    v_lshlrev_b32 v94, 16, v111
    v_and_b32 v95, 0xffff0000, v111
    s_waitcnt lgkmcnt(4)
    v_pk_fma_f32 v[48:49], v[48:49], v[184:185], v[168:169]
    v_pk_fma_f32 v[50:51], v[50:51], v[186:187], v[170:171]
    v_pk_fma_f32 v[52:53], v[52:53], v[188:189], v[172:173]
    v_pk_fma_f32 v[54:55], v[54:55], v[190:191], v[174:175]
    v_pk_fma_f32 v[56:57], v[56:57], v[192:193], v[176:177]
    v_pk_fma_f32 v[58:59], v[58:59], v[194:195], v[178:179]
    s_add_u32 m0, s60, 73728
    s_add_u32 s59, s1, 516096
    buffer_load_dwordx4 v20, s[28:31], s59 offen lds
    v_pk_fma_f32 v[60:61], v[60:61], v[196:197], v[180:181]
    v_pk_fma_f32 v[62:63], v[62:63], v[198:199], v[182:183]
    s_waitcnt lgkmcnt(0)
    v_pk_mul_f32 v[48:49], v[48:49], v[200:201]
    v_pk_mul_f32 v[50:51], v[50:51], v[202:203]
    v_pk_mul_f32 v[52:53], v[52:53], v[204:205]
    v_pk_mul_f32 v[54:55], v[54:55], v[206:207]
    v_pk_mul_f32 v[56:57], v[56:57], v[208:209]
    v_pk_mul_f32 v[58:59], v[58:59], v[210:211]
    v_pk_mul_f32 v[60:61], v[60:61], v[212:213]
    v_pk_mul_f32 v[62:63], v[62:63], v[214:215]
    ds_read_b128 v[220:223], v8 offset:24576
    ds_read_b128 v[216:219], v100 offset:24576
    ds_read_b128 v[228:231], v9 offset:25600
    ds_read_b128 v[224:227], v101 offset:25600
    buffer_load_dwordx4 v20, s[32:35], s59 offen offset:1024 lds
    ds_read_b128 v[232:235], v8 offset:26624
    ds_read_b128 v[236:239], v100 offset:26624
    ds_read_b128 v[240:243], v9 offset:36864
    ds_read_b128 v[244:247], v101 offset:36864
    v_pk_fma_f32 v[32:33], v[48:49], v[80:81], v[32:33]
    v_pk_fma_f32 v[34:35], v[50:51], v[82:83], v[34:35]
    v_pk_fma_f32 v[36:37], v[52:53], v[84:85], v[36:37]
    v_pk_fma_f32 v[38:39], v[54:55], v[86:87], v[38:39]
    v_pk_fma_f32 v[40:41], v[56:57], v[88:89], v[40:41]
    v_pk_fma_f32 v[42:43], v[58:59], v[90:91], v[42:43]
    v_pk_fma_f32 v[44:45], v[60:61], v[92:93], v[44:45]
    v_pk_fma_f32 v[46:47], v[62:63], v[94:95], v[46:47]
    v_pk_add_f32 v[64:65], v[32:33], v[34:35]
    v_pk_mul_f32 v[66:67], v[32:33], v[32:33]
    s_add_u32 m0, s60, 81920
    s_add_u32 s59, s1, 573440
    buffer_load_dwordx4 v20, s[28:31], s59 offen lds
    v_pk_fma_f32 v[66:67], v[34:35], v[34:35], v[66:67]
    v_pk_add_f32 v[64:65], v[64:65], v[36:37]
    v_pk_fma_f32 v[66:67], v[36:37], v[36:37], v[66:67]
    v_pk_add_f32 v[64:65], v[64:65], v[38:39]
    v_pk_fma_f32 v[66:67], v[38:39], v[38:39], v[66:67]
    v_pk_add_f32 v[64:65], v[64:65], v[40:41]
    v_pk_fma_f32 v[66:67], v[40:41], v[40:41], v[66:67]
    v_pk_add_f32 v[64:65], v[64:65], v[42:43]
    v_pk_fma_f32 v[66:67], v[42:43], v[42:43], v[66:67]
    v_pk_add_f32 v[64:65], v[64:65], v[44:45]
    v_pk_fma_f32 v[66:67], v[44:45], v[44:45], v[66:67]
    v_pk_add_f32 v[64:65], v[64:65], v[46:47]
    v_pk_fma_f32 v[66:67], v[46:47], v[46:47], v[66:67]
    v_add_f32 v64, v64, v65
    v_add_f32 v66, v66, v67
    buffer_load_dwordx4 v20, s[32:35], s59 offen offset:1024 lds
    s_nop 0
    v_permlane16_swap_b32 v64, v66
    v_add_f32 v64, v64, v66
    s_nop 1
    v_add_f32_dpp v64, v64, v64 quad_perm:[1,0,3,2] row_mask:0xf bank_mask:0xf
    s_nop 1
    v_add_f32_dpp v64, v64, v64 quad_perm:[2,3,0,1] row_mask:0xf bank_mask:0xf
    s_nop 1
    v_add_f32_dpp v64, v64, v64 row_half_mirror row_mask:0xf bank_mask:0xf
    s_nop 1
    v_add_f32_dpp v64, v64, v64 row_mirror row_mask:0xf bank_mask:0xf
    v_mul_f32 v65, 0x3b124925, v64
    v_mul_f32 v66, 0x3b124925, v64
    s_nop 1
    v_permlane16_swap_b32 v65, v66
    v_fma_f32 v66, -v65, v65, v66
    v_max_f32 v66, 0, v66
    v_add_f32 v66, 0x3727c5ac, v66
    v_rsq_f32 v64, v66
    s_nop 0
    v_mul_f32_e64 v65, -v65, v64
    s_waitcnt lgkmcnt(0)
    s_mov_b32 s57, 6291456
    v_pk_fma_f32 v[48:49], v[32:33], v[64:65], v[64:65] op_sel:[0,0,1] op_sel_hi:[1,0,1]
    v_pk_fma_f32 v[50:51], v[34:35], v[64:65], v[64:65] op_sel:[0,0,1] op_sel_hi:[1,0,1]
    v_pk_fma_f32 v[52:53], v[36:37], v[64:65], v[64:65] op_sel:[0,0,1] op_sel_hi:[1,0,1]
    v_pk_fma_f32 v[54:55], v[38:39], v[64:65], v[64:65] op_sel:[0,0,1] op_sel_hi:[1,0,1]
    v_pk_fma_f32 v[48:49], v[48:49], v[232:233], v[216:217]
    v_pk_fma_f32 v[50:51], v[50:51], v[234:235], v[218:219]
    v_pk_fma_f32 v[52:53], v[52:53], v[236:237], v[220:221]
    v_pk_fma_f32 v[54:55], v[54:55], v[238:239], v[222:223]
    v_cvt_pk_bf16_f32 v104, v48, v49
    v_cvt_pk_bf16_f32 v105, v50, v51
    v_cvt_pk_bf16_f32 v106, v52, v53
    v_cvt_pk_bf16_f32 v107, v54, v55
    buffer_store_dwordx4 v[104:107], v28, s[4:7], s57 offen sc1
    v_pk_fma_f32 v[56:57], v[40:41], v[64:65], v[64:65] op_sel:[0,0,1] op_sel_hi:[1,0,1]
    v_pk_fma_f32 v[58:59], v[42:43], v[64:65], v[64:65] op_sel:[0,0,1] op_sel_hi:[1,0,1]
    v_pk_fma_f32 v[60:61], v[44:45], v[64:65], v[64:65] op_sel:[0,0,1] op_sel_hi:[1,0,1]
    v_pk_fma_f32 v[62:63], v[46:47], v[64:65], v[64:65] op_sel:[0,0,1] op_sel_hi:[1,0,1]
    v_pk_fma_f32 v[56:57], v[56:57], v[240:241], v[224:225]
    v_pk_fma_f32 v[58:59], v[58:59], v[242:243], v[226:227]
    v_pk_fma_f32 v[60:61], v[60:61], v[244:245], v[228:229]
    v_pk_fma_f32 v[62:63], v[62:63], v[246:247], v[230:231]
    v_cvt_pk_bf16_f32 v108, v56, v57
    v_cvt_pk_bf16_f32 v109, v58, v59
    v_cvt_pk_bf16_f32 v110, v60, v61
    v_cvt_pk_bf16_f32 v111, v62, v63
    buffer_store_dwordx4 v[108:111], v29, s[4:7], s57 offen sc1
    v_cvt_pk_bf16_f32 v112, v32, v33
    v_cvt_pk_bf16_f32 v113, v34, v35
    v_cvt_pk_bf16_f32 v114, v36, v37
    v_cvt_pk_bf16_f32 v115, v38, v39
    v_cvt_pk_bf16_f32 v116, v40, v41
    v_cvt_pk_bf16_f32 v117, v42, v43
    v_cvt_pk_bf16_f32 v118, v44, v45
    v_cvt_pk_bf16_f32 v119, v46, v47
    s_lshl_b32 s57, s52, 3
    s_and_b32 s58, s53, 7
    s_add_u32 s57, s57, s58
    s_lshl_b32 s57, s57, 2
    s_lshr_b32 s58, s53, 3
    s_add_u32 s57, s57, s58
    s_lshl_b32 s57, s57, 2
    s_add_u32 s57, s57, s3
    s_lshl_b32 s57, s57, 5
    s_add_u32 s57, s57, 98304
    v_mov_b32 v8, s57
    v_mov_b32 v6, s50
    v_mov_b32 v7, s51
    s_mov_b32 s49, 8388608
    s_cmp_ge_u32 s53, 28
    s_cbranch_scc1 L_h_done
    v_xor_b32 v21, 65536, v21
    v_xor_b32 v22, 65536, v22
    ds_read_b64_tr_b16 a[112:113], v21 offset:0
    s_add_u32 m0, s60, 90112
    s_add_u32 s59, s1, 630784
    buffer_load_dwordx4 v20, s[28:31], s59 offen lds
    ds_read_b64_tr_b16 a[114:115], v21 offset:2048
    ds_read_b64_tr_b16 a[116:117], v22 offset:0
    ds_read_b64_tr_b16 a[118:119], v22 offset:2048
    ds_read_b64_tr_b16 a[120:121], v21 offset:1024
    ds_read_b64_tr_b16 a[122:123], v21 offset:3072
    buffer_load_dwordx4 v20, s[32:35], s59 offen offset:1024 lds
    ds_read_b64_tr_b16 a[124:125], v22 offset:1024
    ds_read_b64_tr_b16 a[126:127], v22 offset:3072
    ds_read_b64_tr_b16 a[128:129], v21 offset:16384
    ds_read_b64_tr_b16 a[130:131], v21 offset:18432
    ds_read_b64_tr_b16 a[132:133], v22 offset:16384
    s_add_u32 m0, s60, 98304
    s_add_u32 s59, s1, 688128
    buffer_load_dwordx4 v20, s[28:31], s59 offen lds
    ds_read_b64_tr_b16 a[134:135], v22 offset:18432
    ds_read_b64_tr_b16 a[136:137], v21 offset:17408
    ds_read_b64_tr_b16 a[138:139], v21 offset:19456
    ds_read_b64_tr_b16 a[140:141], v22 offset:17408
    ds_read_b64_tr_b16 a[142:143], v22 offset:19456
    ds_read_b64_tr_b16 a[144:145], v21 offset:32768
    buffer_load_dwordx4 v20, s[32:35], s59 offen offset:1024 lds
    ds_read_b64_tr_b16 a[146:147], v21 offset:34816
    ds_read_b64_tr_b16 a[148:149], v22 offset:32768
    ds_read_b64_tr_b16 a[150:151], v22 offset:34816
    ds_read_b64_tr_b16 a[152:153], v21 offset:33792
    ds_read_b64_tr_b16 a[154:155], v21 offset:35840
    s_add_u32 m0, s60, 106496
    s_add_u32 s59, s1, 745472
    buffer_load_dwordx4 v20, s[28:31], s59 offen lds
    ds_read_b64_tr_b16 a[156:157], v22 offset:33792
    ds_read_b64_tr_b16 a[158:159], v22 offset:35840
    ds_read_b64_tr_b16 a[160:161], v21 offset:49152
    ds_read_b64_tr_b16 a[162:163], v21 offset:51200
    ds_read_b64_tr_b16 a[164:165], v22 offset:49152
    buffer_load_dwordx4 v20, s[32:35], s59 offen offset:1024 lds
    ds_read_b64_tr_b16 a[166:167], v22 offset:51200
    ds_read_b64_tr_b16 a[168:169], v21 offset:50176
    ds_read_b64_tr_b16 a[170:171], v21 offset:52224
    ds_read_b64_tr_b16 a[172:173], v22 offset:50176
    ds_read_b64_tr_b16 a[174:175], v22 offset:52224
    s_mul_i32 s62, s12, 114688
    s_mul_i32 s63, s3, 7168
    s_add_u32 s62, s62, s63
    s_add_u32 s62, s62, 6291456
    v_add_u32 v2, s63, v11
    s_lshl4_add_u32 s57, s12, s13
    s_lshl2_add_u32 s57, s57, s3
    s_lshl_b32 s57, s57, 5
    s_add_u32 s56, s57, 131072
    v_and_b32 v4, 31, v1
    v_lshrrev_b32 v5, 5, v1
    v_bfe_u32 v10, v1, 1, 3
    v_mul_u32_u24 v9, 896, v4
    s_cmp_lg_u32 s0, 0
    s_cselect_b32 s57, 4, 0
    v_and_b32 v9, 15, v1
    v_mul_u32_u24 v9, 896, v9
    v_lshrrev_b32 v12, 4, v1
    v_xor_b32 v12, v12, v10
    v_xor_b32 v12, s57, v12
    v_xor_b32 v13, 4, v12
    s_mul_i32 s59, s57, 96
    v_add_u32 v9, s59, v9
    v_lshl_add_u32 v12, v12, 4, v9
    s_lshl_b32 s59, s57, 5
    v_add_u32 v9, s59, v9
    v_lshl_add_u32 v13, v13, 4, v9
    s_mul_i32 s59, s57, 224
    s_sub_u32 s59, 512, s59
    v_add_u32 v14, s59, v12
    s_sub_u32 s59, s59, 128
    v_add_u32 v15, s59, v13
    v_add_u32 v28, 6144, v3
    s_and_b32 s46, s15, -4
    s_lshr_b32 s59, s3, 1
    s_add_u32 s13, s46, s59
    s_and_b32 s59, s15, 1
    s_lshl1_add_u32 s13, s13, s59
    s_and_b32 s59, s3, 1
    s_lshl1_add_u32 s13, s13, s59
    s_mul_i32 s65, s46, 114688
    s_mul_i32 s59, s3, 28672
    s_add_u32 s65, s65, s59
    s_add_u32 s65, s65, 10485760
    s_mul_i32 s59, s10, 14336
    s_add_u32 s10, s65, s59
    s_sub_u32 s11, s65, s59
    s_add_u32 s11, s11, 14336
    s_mul_i32 s48, s13, 7168
    s_lshl_b32 s59, s14, 7
    s_add_u32 s48, s48, s59
    v_mov_b32 v16, -1
    v_mov_b32 v17, -1
    v_mov_b32 v18, -1
    v_mov_b32 v19, -1
    s_and_b32 s59, s15, 1
    s_lshl_b32 s59, s59, 2
    s_sub_u32 s59, s59, s3
    s_mul_i32 s59, s59, 14336
    s_add_u32 s65, s65, s59
    s_waitcnt vmcnt(0)
    s_waitcnt lgkmcnt(0)
    s_barrier
    s_add_u32 m0, s63, 0
    s_add_u32 s57, s62, 0
    buffer_load_dwordx4 v11, s[4:7], s57 offen offset:0 sc1 lds
    buffer_load_dwordx4 v11, s[4:7], s57 offen offset:1024 sc1 lds
    buffer_load_dwordx4 v11, s[4:7], s57 offen offset:2048 sc1 lds
    buffer_load_dwordx4 v11, s[4:7], s57 offen offset:3072 sc1 lds
    s_add_u32 m0, s63, 4096
    s_add_u32 s57, s62, 4096
    buffer_load_dwordx4 v11, s[4:7], s57 offen offset:0 sc1 lds
    buffer_load_dwordx4 v11, s[4:7], s57 offen offset:1024 sc1 lds
    buffer_load_dwordx4 v11, s[4:7], s57 offen offset:2048 sc1 lds
    v_xor_b32 v21, 65536, v21
    v_xor_b32 v22, 65536, v22
    ds_read_b64_tr_b16 a[176:177], v21 offset:0
    s_add_u32 m0, s64, 4096
    s_add_u32 s58, s8, 28672
    buffer_load_dwordx4 v3, s[36:39], s58 offen lds
    ds_read_b64_tr_b16 a[178:179], v21 offset:2048
    ds_read_b64_tr_b16 a[180:181], v22 offset:0
    ds_read_b64_tr_b16 a[182:183], v22 offset:2048
    s_add_u32 m0, s64, 5120
    s_add_u32 s58, s8, 35840
    buffer_load_dwordx4 v3, s[36:39], s58 offen lds
    ds_read_b64_tr_b16 a[184:185], v21 offset:1024
    ds_read_b64_tr_b16 a[186:187], v21 offset:3072
    ds_read_b64_tr_b16 a[188:189], v22 offset:1024
    s_add_u32 m0, s64, 6144
    s_add_u32 s58, s8, 43008
    buffer_load_dwordx4 v3, s[36:39], s58 offen lds
    ds_read_b64_tr_b16 a[190:191], v22 offset:3072
    ds_read_b64_tr_b16 a[192:193], v21 offset:16384
    ds_read_b64_tr_b16 a[194:195], v21 offset:18432
    s_add_u32 m0, s64, 7168
    s_add_u32 s58, s8, 50176
    buffer_load_dwordx4 v3, s[36:39], s58 offen lds
    ds_read_b64_tr_b16 a[196:197], v22 offset:16384
    ds_read_b64_tr_b16 a[198:199], v22 offset:18432
    ds_read_b64_tr_b16 a[200:201], v21 offset:17408
    s_add_u32 m0, s64, 8192
    s_add_u32 s58, s8, 57344
    buffer_load_dwordx4 v3, s[36:39], s58 offen lds
    ds_read_b64_tr_b16 a[202:203], v21 offset:19456
    ds_read_b64_tr_b16 a[204:205], v22 offset:17408
    ds_read_b64_tr_b16 a[206:207], v22 offset:19456
    s_add_u32 m0, s64, 9216
    s_add_u32 s58, s8, 64512
    buffer_load_dwordx4 v3, s[36:39], s58 offen lds
    ds_read_b64_tr_b16 a[208:209], v21 offset:32768
    ds_read_b64_tr_b16 a[210:211], v21 offset:34816
    ds_read_b64_tr_b16 a[212:213], v22 offset:32768
    s_add_u32 m0, s64, 10240
    s_add_u32 s58, s8, 71680
    buffer_load_dwordx4 v3, s[36:39], s58 offen lds
    ds_read_b64_tr_b16 a[214:215], v22 offset:34816
    ds_read_b64_tr_b16 a[216:217], v21 offset:33792
    ds_read_b64_tr_b16 a[218:219], v21 offset:35840
    s_add_u32 m0, s64, 11264
    s_add_u32 s58, s8, 78848
    buffer_load_dwordx4 v3, s[36:39], s58 offen lds
    ds_read_b64_tr_b16 a[220:221], v22 offset:33792
    ds_read_b64_tr_b16 a[222:223], v22 offset:35840
    s_waitcnt vmcnt(8)
    ds_read_b128 v[224:227], v2 offset:0
    ds_read_b128 v[228:231], v2 offset:1024
    ds_read_b128 v[232:235], v2 offset:2048
    ds_read_b128 v[236:239], v2 offset:3072
    ds_read_b128 v[240:243], v2 offset:4096
    ds_read_b128 v[244:247], v2 offset:5120
    ds_read_b128 v[248:251], v2 offset:6144
    s_waitcnt lgkmcnt(6)
    v_max3_u32 v10, v224, v225, v226
    v_max_u32 v10, v10, v227
    s_waitcnt lgkmcnt(5)
    v_max3_u32 v10, v10, v228, v229
    v_max3_u32 v10, v10, v230, v231
    s_waitcnt lgkmcnt(4)
    v_max3_u32 v10, v10, v232, v233
    v_max3_u32 v10, v10, v234, v235
    s_waitcnt lgkmcnt(3)
    v_max3_u32 v10, v10, v236, v237
    v_max3_u32 v10, v10, v238, v239
    s_waitcnt lgkmcnt(2)
    v_max3_u32 v10, v10, v240, v241
    v_max3_u32 v10, v10, v242, v243
    s_waitcnt lgkmcnt(1)
    v_max3_u32 v10, v10, v244, v245
    v_max3_u32 v10, v10, v246, v247
    s_waitcnt lgkmcnt(0)
    v_max3_u32 v10, v10, v248, v249
    v_max3_u32 v10, v10, v250, v251
    v_cmp_eq_u32 vcc, -1, v10
    s_cbranch_vccnz L_h0_retry
L_h0_ok:
    s_waitcnt lgkmcnt(0)
    s_barrier
    ds_read_b128 v[32:35], v12 offset:0
    ds_read_b128 v[36:39], v13 offset:0
    s_waitcnt lgkmcnt(0)
    v_mfma_f32_16x16x32_bf16 v[48:51], a[0:3], v[32:35], 0
    ds_read_b128 v[40:43], v12 offset:14336
    ds_read_b128 v[44:47], v13 offset:14336
    v_mfma_f32_16x16x32_bf16 v[48:51], a[16:19], v[36:39], v[48:51]
    s_add_u32 m0, s63, 28672
    s_add_u32 s57, s62, 28672
    v_mfma_f32_16x16x32_bf16 v[52:55], a[4:7], v[32:35], 0
    buffer_load_dwordx4 v11, s[4:7], s57 offen offset:0 sc1 lds
    v_mfma_f32_16x16x32_bf16 v[52:55], a[20:23], v[36:39], v[52:55]
    v_mfma_f32_16x16x32_bf16 v[56:59], a[8:11], v[32:35], 0
    buffer_load_dwordx4 v11, s[4:7], s57 offen offset:1024 sc1 lds
    v_mfma_f32_16x16x32_bf16 v[56:59], a[24:27], v[36:39], v[56:59]
    v_mfma_f32_16x16x32_bf16 v[60:63], a[12:15], v[32:35], 0
    v_mfma_f32_16x16x32_bf16 v[60:63], a[28:31], v[36:39], v[60:63]
    s_waitcnt lgkmcnt(0)
    v_mfma_f32_16x16x32_bf16 v[64:67], a[0:3], v[40:43], 0
    ds_read_b128 v[32:35], v12 offset:128
    ds_read_b128 v[36:39], v13 offset:128
    v_mfma_f32_16x16x32_bf16 v[64:67], a[16:19], v[44:47], v[64:67]
    buffer_load_dwordx4 v11, s[4:7], s57 offen offset:2048 sc1 lds
    v_mfma_f32_16x16x32_bf16 v[68:71], a[4:7], v[40:43], 0
    v_mfma_f32_16x16x32_bf16 v[68:71], a[20:23], v[44:47], v[68:71]
    v_mfma_f32_16x16x32_bf16 v[72:75], a[8:11], v[40:43], 0
    buffer_load_dwordx4 v11, s[4:7], s57 offen offset:3072 sc1 lds
    v_mfma_f32_16x16x32_bf16 v[72:75], a[24:27], v[44:47], v[72:75]
    s_add_u32 m0, s63, 32768
    s_add_u32 s57, s62, 32768
    v_mfma_f32_16x16x32_bf16 v[76:79], a[12:15], v[40:43], 0
    v_mfma_f32_16x16x32_bf16 v[76:79], a[28:31], v[44:47], v[76:79]
    s_waitcnt lgkmcnt(0)
    v_mfma_f32_16x16x32_bf16 v[48:51], a[32:35], v[32:35], v[48:51]
    ds_read_b128 v[40:43], v12 offset:14464
    ds_read_b128 v[44:47], v13 offset:14464
    v_mfma_f32_16x16x32_bf16 v[48:51], a[48:51], v[36:39], v[48:51]
    buffer_load_dwordx4 v11, s[4:7], s57 offen offset:0 sc1 lds
    v_mfma_f32_16x16x32_bf16 v[52:55], a[36:39], v[32:35], v[52:55]
    v_mfma_f32_16x16x32_bf16 v[52:55], a[52:55], v[36:39], v[52:55]
    v_mfma_f32_16x16x32_bf16 v[56:59], a[40:43], v[32:35], v[56:59]
L_pg3:
    s_cbranch_execz L_warm
    buffer_load_dwordx4 v11, s[4:7], s57 offen offset:1024 sc1 lds
    v_mfma_f32_16x16x32_bf16 v[56:59], a[56:59], v[36:39], v[56:59]
    v_mfma_f32_16x16x32_bf16 v[60:63], a[44:47], v[32:35], v[60:63]
    v_mfma_f32_16x16x32_bf16 v[60:63], a[60:63], v[36:39], v[60:63]
    s_waitcnt lgkmcnt(0)
    v_mfma_f32_16x16x32_bf16 v[64:67], a[32:35], v[40:43], v[64:67]
    ds_read_b128 v[32:35], v12 offset:256
    ds_read_b128 v[36:39], v13 offset:256
    v_mfma_f32_16x16x32_bf16 v[64:67], a[48:51], v[44:47], v[64:67]
    buffer_load_dwordx4 v11, s[4:7], s57 offen offset:2048 sc1 lds
    v_mfma_f32_16x16x32_bf16 v[68:71], a[36:39], v[40:43], v[68:71]
    v_mfma_f32_16x16x32_bf16 v[68:71], a[52:55], v[44:47], v[68:71]
    s_add_u32 m0, s16, 0
    s_add_u32 s58, s8, 86016
    v_mfma_f32_16x16x32_bf16 v[72:75], a[40:43], v[40:43], v[72:75]
    v_mfma_f32_16x16x32_bf16 v[72:75], a[56:59], v[44:47], v[72:75]
    v_mfma_f32_16x16x32_bf16 v[76:79], a[44:47], v[40:43], v[76:79]
    buffer_load_dwordx4 v3, s[36:39], s58 offen lds
    v_mfma_f32_16x16x32_bf16 v[76:79], a[60:63], v[44:47], v[76:79]
    s_waitcnt lgkmcnt(0)
    v_mfma_f32_16x16x32_bf16 v[48:51], a[64:67], v[32:35], v[48:51]
    ds_read_b128 v[40:43], v12 offset:14592
    ds_read_b128 v[44:47], v13 offset:14592
    v_mfma_f32_16x16x32_bf16 v[48:51], a[80:83], v[36:39], v[48:51]
    ds_read_b64_tr_b16 a[224:225], v23 offset:0
    v_mfma_f32_16x16x32_bf16 v[52:55], a[68:71], v[32:35], v[52:55]
    ds_read_b64_tr_b16 a[226:227], v23 offset:2048
    ds_read_b64_tr_b16 a[228:229], v23 offset:32
    v_mfma_f32_16x16x32_bf16 v[52:55], a[84:87], v[36:39], v[52:55]
    buffer_load_dwordx4 v28, s[36:39], s58 offen offset:1024 lds
    v_mfma_f32_16x16x32_bf16 v[56:59], a[72:75], v[32:35], v[56:59]
    ds_read_b64_tr_b16 a[230:231], v23 offset:2080
    ds_read_b64_tr_b16 a[232:233], v23 offset:512
    v_mfma_f32_16x16x32_bf16 v[56:59], a[88:91], v[36:39], v[56:59]
    s_add_u32 m0, s16, 2048
    s_add_u32 s58, s8, 100352
    v_mfma_f32_16x16x32_bf16 v[60:63], a[76:79], v[32:35], v[60:63]
    ds_read_b64_tr_b16 a[234:235], v23 offset:2560
    ds_read_b64_tr_b16 a[236:237], v23 offset:544
    v_mfma_f32_16x16x32_bf16 v[60:63], a[92:95], v[36:39], v[60:63]
    ds_read_b64_tr_b16 a[238:239], v23 offset:2592
    s_waitcnt lgkmcnt(8)
    v_mfma_f32_16x16x32_bf16 v[64:67], a[64:67], v[40:43], v[64:67]
    ds_read_b128 v[32:35], v12 offset:384
    ds_read_b128 v[36:39], v15 offset:0
    s_waitcnt vmcnt(13)
    v_mfma_f32_16x16x32_bf16 v[64:67], a[80:83], v[44:47], v[64:67]
    buffer_load_dwordx4 v3, s[36:39], s58 offen lds
    v_mfma_f32_16x16x32_bf16 v[68:71], a[68:71], v[40:43], v[68:71]
    ds_read_b64_tr_b16 a[240:241], v23 offset:4096
    ds_read_b64_tr_b16 a[242:243], v23 offset:6144
    v_mfma_f32_16x16x32_bf16 v[68:71], a[84:87], v[44:47], v[68:71]
    ds_read_b64_tr_b16 a[244:245], v23 offset:4128
    ds_read_b64_tr_b16 a[246:247], v23 offset:6176
    v_mfma_f32_16x16x32_bf16 v[72:75], a[72:75], v[40:43], v[72:75]
    ds_read_b64_tr_b16 a[248:249], v23 offset:4608
    v_mfma_f32_16x16x32_bf16 v[72:75], a[88:91], v[44:47], v[72:75]
    buffer_load_dwordx4 v28, s[36:39], s58 offen offset:1024 lds
    v_mfma_f32_16x16x32_bf16 v[76:79], a[76:79], v[40:43], v[76:79]
    ds_read_b64_tr_b16 a[250:251], v23 offset:6656
    ds_read_b64_tr_b16 a[252:253], v23 offset:4640
    v_mfma_f32_16x16x32_bf16 v[76:79], a[92:95], v[44:47], v[76:79]
    s_add_u32 m0, s16, 4096
    s_waitcnt lgkmcnt(7)
    v_mfma_f32_16x16x32_bf16 v[48:51], a[96:99], v[32:35], v[48:51]
    ds_read_b128 v[40:43], v12 offset:14720
    ds_read_b128 v[44:47], v15 offset:14336
    v_mfma_f32_16x16x32_bf16 v[48:51], a[112:115], v[36:39], v[48:51]
    s_add_u32 s58, s8, 114688
    ds_read_b64_tr_b16 a[254:255], v23 offset:6688
    v_mfma_f32_16x16x32_bf16 v[52:55], a[100:103], v[32:35], v[52:55]
    buffer_load_dwordx4 v3, s[36:39], s58 offen lds
    v_mfma_f32_16x16x32_bf16 v[52:55], a[116:119], v[36:39], v[52:55]
    v_mfma_f32_16x16x32_bf16 v[56:59], a[104:107], v[32:35], v[56:59]
    v_mfma_f32_16x16x32_bf16 v[56:59], a[120:123], v[36:39], v[56:59]
    v_mfma_f32_16x16x32_bf16 v[60:63], a[108:111], v[32:35], v[60:63]
    v_mfma_f32_16x16x32_bf16 v[60:63], a[124:127], v[36:39], v[60:63]
    s_waitcnt lgkmcnt(1)
    v_mfma_f32_16x16x32_bf16 v[64:67], a[96:99], v[40:43], v[64:67]
    buffer_load_dwordx4 v28, s[36:39], s58 offen offset:1024 lds
    ds_read_b128 v[32:35], v14 offset:0
    ds_read_b128 v[36:39], v15 offset:128
    v_mfma_f32_16x16x32_bf16 v[64:67], a[112:115], v[44:47], v[64:67]
    s_add_u32 m0, s16, 6144
    s_add_u32 s58, s8, 129024
    v_mfma_f32_16x16x32_bf16 v[68:71], a[100:103], v[40:43], v[68:71]
    v_mfma_f32_16x16x32_bf16 v[68:71], a[116:119], v[44:47], v[68:71]
    v_mfma_f32_16x16x32_bf16 v[72:75], a[104:107], v[40:43], v[72:75]
    buffer_load_dwordx4 v3, s[36:39], s58 offen lds
    v_mfma_f32_16x16x32_bf16 v[72:75], a[120:123], v[44:47], v[72:75]
    v_mfma_f32_16x16x32_bf16 v[76:79], a[108:111], v[40:43], v[76:79]
    v_mfma_f32_16x16x32_bf16 v[76:79], a[124:127], v[44:47], v[76:79]
    s_waitcnt lgkmcnt(0)
    v_mfma_f32_16x16x32_bf16 v[48:51], a[128:131], v[32:35], v[48:51]
    ds_read_b128 v[40:43], v14 offset:14336
    ds_read_b128 v[44:47], v15 offset:14464
    v_mfma_f32_16x16x32_bf16 v[48:51], a[144:147], v[36:39], v[48:51]
    buffer_load_dwordx4 v28, s[36:39], s58 offen offset:1024 lds
    v_mfma_f32_16x16x32_bf16 v[52:55], a[132:135], v[32:35], v[52:55]
    v_mfma_f32_16x16x32_bf16 v[52:55], a[148:151], v[36:39], v[52:55]
    s_add_u32 m0, s16, 8192
    s_add_u32 s58, s8, 143360
    v_mfma_f32_16x16x32_bf16 v[56:59], a[136:139], v[32:35], v[56:59]
    v_mfma_f32_16x16x32_bf16 v[56:59], a[152:155], v[36:39], v[56:59]
    v_mfma_f32_16x16x32_bf16 v[60:63], a[140:143], v[32:35], v[60:63]
    buffer_load_dwordx4 v3, s[36:39], s58 offen lds
    v_mfma_f32_16x16x32_bf16 v[60:63], a[156:159], v[36:39], v[60:63]
    s_waitcnt lgkmcnt(0)
    v_mfma_f32_16x16x32_bf16 v[64:67], a[128:131], v[40:43], v[64:67]
    ds_read_b128 v[32:35], v14 offset:128
    ds_read_b128 v[36:39], v15 offset:256
    v_mfma_f32_16x16x32_bf16 v[64:67], a[144:147], v[44:47], v[64:67]
    v_mfma_f32_16x16x32_bf16 v[68:71], a[132:135], v[40:43], v[68:71]
    v_mfma_f32_16x16x32_bf16 v[68:71], a[148:151], v[44:47], v[68:71]
    buffer_load_dwordx4 v28, s[36:39], s58 offen offset:1024 lds
    v_mfma_f32_16x16x32_bf16 v[72:75], a[136:139], v[40:43], v[72:75]
    s_waitcnt vmcnt(10)
    ds_read_b128 v[224:227], v2 offset:28672
    v_mfma_f32_16x16x32_bf16 v[72:75], a[152:155], v[44:47], v[72:75]
    ds_read_b128 v[228:231], v2 offset:29696
    ds_read_b128 v[232:235], v2 offset:30720
    v_mfma_f32_16x16x32_bf16 v[76:79], a[140:143], v[40:43], v[76:79]
    ds_read_b128 v[236:239], v2 offset:31744
    ds_read_b128 v[240:243], v2 offset:32768
    v_mfma_f32_16x16x32_bf16 v[76:79], a[156:159], v[44:47], v[76:79]
    ds_read_b128 v[244:247], v2 offset:33792
    s_waitcnt lgkmcnt(6)
    v_mfma_f32_16x16x32_bf16 v[48:51], a[160:163], v[32:35], v[48:51]
    ds_read_b128 v[40:43], v14 offset:14464
    ds_read_b128 v[44:47], v15 offset:14592
    v_mfma_f32_16x16x32_bf16 v[48:51], a[176:179], v[36:39], v[48:51]
    buffer_store_dwordx4 v[112:115], v26, s[4:7], s49 offen sc1
    v_mfma_f32_16x16x32_bf16 v[52:55], a[164:167], v[32:35], v[52:55]
    ds_read_b128 v[248:251], v2 offset:34816
    s_waitcnt lgkmcnt(8)
    v_mfma_f32_16x16x32_bf16 v[52:55], a[180:183], v[36:39], v[52:55]
    v_max3_u32 v10, v224, v225, v226
    v_max_u32 v10, v10, v227
    v_mfma_f32_16x16x32_bf16 v[56:59], a[168:171], v[32:35], v[56:59]
    s_waitcnt lgkmcnt(7)
    v_max3_u32 v10, v10, v228, v229
    v_mfma_f32_16x16x32_bf16 v[56:59], a[184:187], v[36:39], v[56:59]
    v_max3_u32 v10, v10, v230, v231
    s_waitcnt lgkmcnt(6)
    v_mfma_f32_16x16x32_bf16 v[60:63], a[172:175], v[32:35], v[60:63]
    buffer_store_dwordx4 v[116:119], v27, s[4:7], s49 offen sc1
    v_mfma_f32_16x16x32_bf16 v[60:63], a[188:191], v[36:39], v[60:63]
    s_add_u32 m0, s16, 10240
    s_waitcnt lgkmcnt(1)
    v_mfma_f32_16x16x32_bf16 v[64:67], a[160:163], v[40:43], v[64:67]
    ds_read_b128 v[32:35], v14 offset:256
    ds_read_b128 v[36:39], v15 offset:384
    v_mfma_f32_16x16x32_bf16 v[64:67], a[176:179], v[44:47], v[64:67]
    s_add_u32 s58, s8, 157696
    v_max3_u32 v10, v10, v232, v233
    v_mfma_f32_16x16x32_bf16 v[68:71], a[164:167], v[40:43], v[68:71]
    buffer_load_dwordx4 v3, s[36:39], s58 offen lds
    v_mfma_f32_16x16x32_bf16 v[68:71], a[180:183], v[44:47], v[68:71]
    v_max3_u32 v10, v10, v234, v235
    v_max3_u32 v10, v10, v236, v237
    v_mfma_f32_16x16x32_bf16 v[72:75], a[168:171], v[40:43], v[72:75]
    v_max3_u32 v10, v10, v238, v239
    v_max3_u32 v10, v10, v240, v241
    v_mfma_f32_16x16x32_bf16 v[72:75], a[184:187], v[44:47], v[72:75]
    v_max3_u32 v10, v10, v242, v243
    v_max3_u32 v10, v10, v244, v245
    v_mfma_f32_16x16x32_bf16 v[76:79], a[172:175], v[40:43], v[76:79]
    v_max3_u32 v10, v10, v246, v247
    s_waitcnt lgkmcnt(2)
    v_mfma_f32_16x16x32_bf16 v[76:79], a[188:191], v[44:47], v[76:79]
    v_max3_u32 v10, v10, v248, v249
    s_waitcnt lgkmcnt(0)
    v_mfma_f32_16x16x32_bf16 v[48:51], a[192:195], v[32:35], v[48:51]
    buffer_load_dwordx4 v28, s[36:39], s58 offen offset:1024 lds
    ds_read_b128 v[40:43], v14 offset:14592
    ds_read_b128 v[44:47], v15 offset:14720
    v_mfma_f32_16x16x32_bf16 v[48:51], a[208:211], v[36:39], v[48:51]
    s_add_u32 m0, s64, 0
    s_add_u32 s58, s8, 172032
    v_mfma_f32_16x16x32_bf16 v[52:55], a[196:199], v[32:35], v[52:55]
    v_max3_u32 v10, v10, v250, v251
    ds_read_b64_tr_b16 v[112:113], v23 offset:8192
    v_mfma_f32_16x16x32_bf16 v[52:55], a[212:215], v[36:39], v[52:55]
    ds_read_b64_tr_b16 v[114:115], v23 offset:10240
    ds_read_b64_tr_b16 v[116:117], v23 offset:8224
    v_mfma_f32_16x16x32_bf16 v[56:59], a[200:203], v[32:35], v[56:59]
    buffer_load_dwordx4 v3, s[36:39], s58 offen lds
    v_mfma_f32_16x16x32_bf16 v[56:59], a[216:219], v[36:39], v[56:59]
    ds_read_b64_tr_b16 v[118:119], v23 offset:10272
    ds_read_b64_tr_b16 v[120:121], v23 offset:8704
    v_mfma_f32_16x16x32_bf16 v[60:63], a[204:207], v[32:35], v[60:63]
    ds_read_b64_tr_b16 v[122:123], v23 offset:10752
    ds_read_b64_tr_b16 v[124:125], v23 offset:8736
    v_mfma_f32_16x16x32_bf16 v[60:63], a[220:223], v[36:39], v[60:63]
    ds_read_b64_tr_b16 v[126:127], v23 offset:10784
    s_waitcnt lgkmcnt(8)
    v_mfma_f32_16x16x32_bf16 v[64:67], a[192:195], v[40:43], v[64:67]
    v_cmp_eq_u32 vcc, -1, v10
    s_cbranch_vccnz L_h1_retry
L_h1_ok:
    s_barrier
    ds_read_b128 v[32:35], v12 offset:28672
    ds_read_b128 v[36:39], v13 offset:28672
    v_mfma_f32_16x16x32_bf16 v[64:67], a[208:211], v[44:47], v[64:67]
    buffer_load_dwordx4 v28, s[36:39], s58 offen offset:1024 lds
    v_mfma_f32_16x16x32_bf16 v[68:71], a[196:199], v[40:43], v[68:71]
    s_add_u32 m0, s63, 0
    s_add_u32 s57, s62, 57344
    v_mfma_f32_16x16x32_bf16 v[68:71], a[212:215], v[44:47], v[68:71]
    v_mfma_f32_16x16x32_bf16 v[72:75], a[200:203], v[40:43], v[72:75]
    v_mfma_f32_16x16x32_bf16 v[72:75], a[216:219], v[44:47], v[72:75]
    buffer_load_dwordx4 v11, s[4:7], s57 offen offset:0 sc1 lds
    v_mfma_f32_16x16x32_bf16 v[76:79], a[204:207], v[40:43], v[76:79]
    v_mfma_f32_16x16x32_bf16 v[76:79], a[220:223], v[44:47], v[76:79]
    s_waitcnt lgkmcnt(0)
    v_mfma_f32_16x16x32_bf16 v[80:83], a[0:3], v[32:35], 0
    ds_read_b128 v[40:43], v12 offset:43008
    ds_read_b128 v[44:47], v13 offset:43008
    v_mfma_f32_16x16x32_bf16 v[80:83], a[16:19], v[36:39], v[80:83]
    buffer_load_dwordx4 v11, s[4:7], s57 offen offset:1024 sc1 lds
    v_mfma_f32_16x16x32_bf16 v[84:87], a[4:7], v[32:35], 0
    v_mfma_f32_16x16x32_bf16 v[84:87], a[20:23], v[36:39], v[84:87]
    v_mfma_f32_16x16x32_bf16 v[88:91], a[8:11], v[32:35], 0
    v_mfma_f32_16x16x32_bf16 v[88:91], a[24:27], v[36:39], v[88:91]
    buffer_load_dwordx4 v11, s[4:7], s57 offen offset:2048 sc1 lds
    v_mfma_f32_16x16x32_bf16 v[92:95], a[12:15], v[32:35], 0
    v_mul_f32 v48, v48, v56
    v_mfma_f32_16x16x32_bf16 v[92:95], a[28:31], v[36:39], v[92:95]
    v_mul_f32 v49, v49, v57
    s_waitcnt lgkmcnt(0)
    v_mfma_f32_16x16x32_bf16 v[96:99], a[0:3], v[40:43], 0
    ds_read_b128 v[32:35], v12 offset:28800
    ds_read_b128 v[36:39], v13 offset:28800
    v_mfma_f32_16x16x32_bf16 v[96:99], a[16:19], v[44:47], v[96:99]
    buffer_load_dwordx4 v11, s[4:7], s57 offen offset:3072 sc1 lds
    v_mfma_f32_16x16x32_bf16 v[100:103], a[4:7], v[40:43], 0
    s_add_u32 m0, s63, 4096
    s_add_u32 s57, s62, 61440
    v_mfma_f32_16x16x32_bf16 v[100:103], a[20:23], v[44:47], v[100:103]
    v_mul_f32 v50, v50, v58
    v_mul_f32 v51, v51, v59
    v_mfma_f32_16x16x32_bf16 v[104:107], a[8:11], v[40:43], 0
    v_mul_f32 v52, v52, v60
    v_mul_f32 v53, v53, v61
    v_mfma_f32_16x16x32_bf16 v[104:107], a[24:27], v[44:47], v[104:107]
    buffer_load_dwordx4 v11, s[4:7], s57 offen offset:0 sc1 lds
    v_mfma_f32_16x16x32_bf16 v[108:111], a[12:15], v[40:43], 0
    v_mul_f32 v54, v54, v62
    v_mul_f32 v55, v55, v63
    v_mfma_f32_16x16x32_bf16 v[108:111], a[28:31], v[44:47], v[108:111]
    v_cvt_pk_bf16_f32 v56, v48, v49
    s_waitcnt lgkmcnt(0)
    v_mfma_f32_16x16x32_bf16 v[80:83], a[32:35], v[32:35], v[80:83]
    ds_read_b128 v[40:43], v12 offset:43136
    ds_read_b128 v[44:47], v13 offset:43136
    v_mfma_f32_16x16x32_bf16 v[80:83], a[48:51], v[36:39], v[80:83]
    buffer_load_dwordx4 v11, s[4:7], s57 offen offset:1024 sc1 lds
    v_mfma_f32_16x16x32_bf16 v[84:87], a[36:39], v[32:35], v[84:87]
    v_cvt_pk_bf16_f32 v57, v50, v51
    v_cvt_pk_bf16_f32 v58, v52, v53
    v_mfma_f32_16x16x32_bf16 v[84:87], a[52:55], v[36:39], v[84:87]
    v_cvt_pk_bf16_f32 v59, v54, v55
    v_mfma_f32_16x16x32_bf16 v[88:91], a[40:43], v[32:35], v[88:91]
    v_mfma_f32_16x16x32_bf16 v[88:91], a[56:59], v[36:39], v[88:91]
    buffer_load_dwordx4 v11, s[4:7], s57 offen offset:2048 sc1 lds
    v_mfma_f32_16x16x32_bf16 v[92:95], a[44:47], v[32:35], v[92:95]
    v_mul_f32 v64, v64, v72
    v_mul_f32 v65, v65, v73
    v_mfma_f32_16x16x32_bf16 v[92:95], a[60:63], v[36:39], v[92:95]
    s_add_u32 s59, s61, 0
    s_waitcnt lgkmcnt(0)
    v_mfma_f32_16x16x32_bf16 v[96:99], a[32:35], v[40:43], v[96:99]
    ds_read_b128 v[32:35], v12 offset:28928
    ds_read_b128 v[36:39], v13 offset:28928
    v_mfma_f32_16x16x32_bf16 v[96:99], a[48:51], v[44:47], v[96:99]
    v_mul_f32 v66, v66, v74
    v_mul_f32 v67, v67, v75
    v_mfma_f32_16x16x32_bf16 v[100:103], a[36:39], v[40:43], v[100:103]
    v_mul_f32 v68, v68, v76
    v_mul_f32 v69, v69, v77
    v_mfma_f32_16x16x32_bf16 v[100:103], a[52:55], v[44:47], v[100:103]
    buffer_store_dwordx4 v[56:59], v11, s[4:7], s59 offen sc1
    v_mfma_f32_16x16x32_bf16 v[104:107], a[40:43], v[40:43], v[104:107]
    s_add_u32 m0, s64, 2048
    s_add_u32 s58, s8, 186368
    v_mfma_f32_16x16x32_bf16 v[104:107], a[56:59], v[44:47], v[104:107]
    v_mul_f32 v70, v70, v78
    v_mul_f32 v71, v71, v79
    v_mfma_f32_16x16x32_bf16 v[108:111], a[44:47], v[40:43], v[108:111]
    v_cvt_pk_bf16_f32 v72, v64, v65
    v_mfma_f32_16x16x32_bf16 v[108:111], a[60:63], v[44:47], v[108:111]
    v_cvt_pk_bf16_f32 v73, v66, v67
    s_waitcnt lgkmcnt(0)
    v_mfma_f32_16x16x32_bf16 v[80:83], a[64:67], v[32:35], v[80:83]
    buffer_load_dwordx4 v3, s[36:39], s58 offen lds
    ds_read_b128 v[40:43], v12 offset:43264
    ds_read_b128 v[44:47], v13 offset:43264
    v_mfma_f32_16x16x32_bf16 v[80:83], a[80:83], v[36:39], v[80:83]
    v_cvt_pk_bf16_f32 v74, v68, v69
    v_cvt_pk_bf16_f32 v75, v70, v71
    v_mfma_f32_16x16x32_bf16 v[84:87], a[68:71], v[32:35], v[84:87]
    s_waitcnt vmcnt(21)
    ds_read_b64_tr_b16 v[128:129], v0 offset:0
    v_mfma_f32_16x16x32_bf16 v[84:87], a[84:87], v[36:39], v[84:87]
    ds_read_b64_tr_b16 v[130:131], v0 offset:2048
    ds_read_b64_tr_b16 v[132:133], v0 offset:32
    v_mfma_f32_16x16x32_bf16 v[88:91], a[72:75], v[32:35], v[88:91]
    buffer_load_dwordx4 v28, s[36:39], s58 offen offset:1024 lds
    v_mfma_f32_16x16x32_bf16 v[88:91], a[88:91], v[36:39], v[88:91]
    ds_read_b64_tr_b16 v[134:135], v0 offset:2080
    ds_read_b64_tr_b16 v[136:137], v0 offset:512
    v_mfma_f32_16x16x32_bf16 v[92:95], a[76:79], v[32:35], v[92:95]
    s_add_u32 s59, s61, 57344
    ds_read_b64_tr_b16 v[138:139], v0 offset:2560
    v_mfma_f32_16x16x32_bf16 v[92:95], a[92:95], v[36:39], v[92:95]
    ds_read_b64_tr_b16 v[140:141], v0 offset:544
    s_waitcnt lgkmcnt(7)
    v_mfma_f32_16x16x32_bf16 v[96:99], a[64:67], v[40:43], v[96:99]
    ds_read_b128 v[32:35], v12 offset:29056
    ds_read_b128 v[36:39], v15 offset:28672
    v_mfma_f32_16x16x32_bf16 v[96:99], a[80:83], v[44:47], v[96:99]
    s_lshl_b32 s45, s13, 7
    s_add_u32 s45, s45, 98304
    v_mfma_f32_16x16x32_bf16 v[100:103], a[68:71], v[40:43], v[100:103]
    buffer_store_dwordx4 v[72:75], v11, s[4:7], s59 offen sc1
    v_mfma_f32_16x16x32_bf16 v[100:103], a[84:87], v[44:47], v[100:103]
    s_add_u32 m0, s64, 4096
    s_add_u32 s58, s9, 0
    v_mfma_f32_16x16x32_bf16 v[104:107], a[72:75], v[40:43], v[104:107]
    v_and_b32 v9, 3, v1
    v_lshl_add_u32 v9, v9, 5, s45
    v_mfma_f32_16x16x32_bf16 v[104:107], a[88:91], v[44:47], v[104:107]
    v_bfe_u32 v22, v1, 2, 1
    v_lshl_add_u32 v9, v22, 10, v9
    v_mfma_f32_16x16x32_bf16 v[108:111], a[76:79], v[40:43], v[108:111]
    buffer_load_dwordx4 v3, s[36:39], s58 offen lds
    v_mfma_f32_16x16x32_bf16 v[108:111], a[92:95], v[44:47], v[108:111]
    s_lshr_b32 s45, s46, 2
    s_waitcnt lgkmcnt(0)
    v_mfma_f32_16x16x32_bf16 v[80:83], a[96:99], v[32:35], v[80:83]
    ds_read_b128 v[40:43], v12 offset:43392
    ds_read_b128 v[44:47], v15 offset:43008
    v_mfma_f32_16x16x32_bf16 v[80:83], a[112:115], v[36:39], v[80:83]
    s_lshl_b32 s45, s45, 6
    s_mul_i32 s47, s3, 14
    v_mfma_f32_16x16x32_bf16 v[84:87], a[100:103], v[32:35], v[84:87]
    s_add_u32 s45, s45, s47
    s_lshl_b32 s45, s45, 5
    v_mfma_f32_16x16x32_bf16 v[84:87], a[116:119], v[36:39], v[84:87]
    buffer_load_dwordx4 v28, s[36:39], s58 offen offset:1024 lds
    v_mfma_f32_16x16x32_bf16 v[88:91], a[104:107], v[32:35], v[88:91]
    s_add_u32 s45, s45, 131072
    v_min_u32 v22, 13, v1
    v_mfma_f32_16x16x32_bf16 v[88:91], a[120:123], v[36:39], v[88:91]
    s_waitcnt vmcnt(17)
    v_lshl_add_u32 v22, v22, 5, s45
    v_mfma_f32_16x16x32_bf16 v[92:95], a[108:111], v[32:35], v[92:95]
    v_cmp_gt_u32 s[0:1], 16, v1
    s_nop 1
    v_mfma_f32_16x16x32_bf16 v[92:95], a[124:127], v[36:39], v[92:95]
    ds_read_b64_tr_b16 v[142:143], v0 offset:2592
    s_waitcnt lgkmcnt(1)
    v_mfma_f32_16x16x32_bf16 v[96:99], a[96:99], v[40:43], v[96:99]
    ds_read_b128 v[32:35], v14 offset:28672
    ds_read_b128 v[36:39], v15 offset:28800
    v_mfma_f32_16x16x32_bf16 v[96:99], a[112:115], v[44:47], v[96:99]
    s_mov_b64 exec, 1
    buffer_store_dwordx2 v[6:7], v8, s[4:7], 0 offen sc1
    s_mov_b64 exec, -1
    v_mfma_f32_16x16x32_bf16 v[100:103], a[100:103], v[40:43], v[100:103]
    s_add_u32 m0, s64, 6144
    s_add_u32 s58, s9, 14336
    v_mfma_f32_16x16x32_bf16 v[100:103], a[116:119], v[44:47], v[100:103]
    v_cndmask_b32 v9, v9, v22, s[0:1]
    s_lshr_b32 s45, s46, 2
    v_mfma_f32_16x16x32_bf16 v[104:107], a[104:107], v[40:43], v[104:107]
    s_lshl_b32 s45, s45, 6
    s_add_u32 s45, s45, 73728
    v_mfma_f32_16x16x32_bf16 v[104:107], a[120:123], v[44:47], v[104:107]
    buffer_load_dwordx4 v3, s[36:39], s58 offen lds
    v_mfma_f32_16x16x32_bf16 v[108:111], a[108:111], v[40:43], v[108:111]
    v_and_b32 v22, 1, v1
    v_lshl_add_u32 v22, v22, 5, s45
    v_mfma_f32_16x16x32_bf16 v[108:111], a[124:127], v[44:47], v[108:111]
    v_cmp_le_u32 s[0:1], 32, v1
    s_nop 1
    s_waitcnt lgkmcnt(0)
    v_mfma_f32_16x16x32_bf16 v[80:83], a[128:131], v[32:35], v[80:83]
    ds_read_b128 v[40:43], v14 offset:43008
    ds_read_b128 v[44:47], v15 offset:43136
    v_mfma_f32_16x16x32_bf16 v[80:83], a[144:147], v[36:39], v[80:83]
    v_cndmask_b32 v9, v9, v22, s[0:1]
    ds_read_b64_tr_b16 v[144:145], v0 offset:4096
    v_mfma_f32_16x16x32_bf16 v[84:87], a[132:135], v[32:35], v[84:87]
    buffer_load_dwordx4 v28, s[36:39], s58 offen offset:1024 lds
    v_mfma_f32_16x16x32_bf16 v[84:87], a[148:151], v[36:39], v[84:87]
    s_lshl_b32 s47, s12, 6
    s_add_u32 s47, s47, 73728
    v_mfma_f32_16x16x32_bf16 v[88:91], a[136:139], v[32:35], v[88:91]
    s_add_u32 m0, s64, 8192
    s_add_u32 s58, s9, 28672
    v_mfma_f32_16x16x32_bf16 v[88:91], a[152:155], v[36:39], v[88:91]
    s_sub_u32 s47, s47, s45
    v_add_u32 v22, s47, v22
    v_mfma_f32_16x16x32_bf16 v[92:95], a[140:143], v[32:35], v[92:95]
    v_cmp_le_u32 s[0:1], 48, v1
    s_nop 1
    v_mfma_f32_16x16x32_bf16 v[92:95], a[156:159], v[36:39], v[92:95]
    v_cndmask_b32 v9, v9, v22, s[0:1]
    s_waitcnt lgkmcnt(1)
    v_mfma_f32_16x16x32_bf16 v[96:99], a[128:131], v[40:43], v[96:99]
    buffer_load_dwordx4 v3, s[36:39], s58 offen lds
    ds_read_b128 v[32:35], v14 offset:28800
    ds_read_b128 v[36:39], v15 offset:28928
    v_mfma_f32_16x16x32_bf16 v[96:99], a[144:147], v[44:47], v[96:99]
    ds_read_b64_tr_b16 v[146:147], v0 offset:6144
    ds_read_b64_tr_b16 v[148:149], v0 offset:4128
    v_mfma_f32_16x16x32_bf16 v[100:103], a[132:135], v[40:43], v[100:103]
    ds_read_b64_tr_b16 v[150:151], v0 offset:6176
    ds_read_b64_tr_b16 v[152:153], v0 offset:4608
    v_mfma_f32_16x16x32_bf16 v[100:103], a[148:151], v[44:47], v[100:103]
    ds_read_b64_tr_b16 v[154:155], v0 offset:6656
    ds_read_b64_tr_b16 v[156:157], v0 offset:4640
    v_mfma_f32_16x16x32_bf16 v[104:107], a[136:139], v[40:43], v[104:107]
    buffer_load_dwordx4 v28, s[36:39], s58 offen offset:1024 lds
    v_mfma_f32_16x16x32_bf16 v[104:107], a[152:155], v[44:47], v[104:107]
    s_waitcnt vmcnt(11)
    ds_read_b128 v[224:227], v2 offset:0
    v_mfma_f32_16x16x32_bf16 v[108:111], a[140:143], v[40:43], v[108:111]
    s_add_u32 m0, s64, 10240
    s_add_u32 s58, s9, 43008
    v_mfma_f32_16x16x32_bf16 v[108:111], a[156:159], v[44:47], v[108:111]
    ds_read_b128 v[228:231], v2 offset:1024
    s_waitcnt lgkmcnt(8)
    v_mfma_f32_16x16x32_bf16 v[80:83], a[160:163], v[32:35], v[80:83]
    ds_read_b128 v[40:43], v14 offset:43136
    ds_read_b128 v[44:47], v15 offset:43264
    v_mfma_f32_16x16x32_bf16 v[80:83], a[176:179], v[36:39], v[80:83]
    buffer_load_dwordx4 v3, s[36:39], s58 offen lds
    v_mfma_f32_16x16x32_bf16 v[84:87], a[164:167], v[32:35], v[84:87]
    ds_read_b128 v[232:235], v2 offset:2048
    ds_read_b128 v[236:239], v2 offset:3072
    v_mfma_f32_16x16x32_bf16 v[84:87], a[180:183], v[36:39], v[84:87]
    ds_read_b128 v[240:243], v2 offset:4096
    ds_read_b128 v[244:247], v2 offset:5120
    v_mfma_f32_16x16x32_bf16 v[88:91], a[168:171], v[32:35], v[88:91]
    ds_read_b128 v[248:251], v2 offset:6144
    s_waitcnt lgkmcnt(8)
    v_mfma_f32_16x16x32_bf16 v[88:91], a[184:187], v[36:39], v[88:91]
    v_max3_u32 v10, v224, v225, v226
    v_max_u32 v10, v10, v227
    v_mfma_f32_16x16x32_bf16 v[92:95], a[172:175], v[32:35], v[92:95]
    buffer_load_dwordx4 v28, s[36:39], s58 offen offset:1024 lds
    v_mfma_f32_16x16x32_bf16 v[92:95], a[188:191], v[36:39], v[92:95]
    s_waitcnt lgkmcnt(7)
    s_waitcnt lgkmcnt(5)
    v_mfma_f32_16x16x32_bf16 v[96:99], a[160:163], v[40:43], v[96:99]
    ds_read_b128 v[32:35], v14 offset:28928
    ds_read_b128 v[36:39], v15 offset:29056
    v_mfma_f32_16x16x32_bf16 v[96:99], a[176:179], v[44:47], v[96:99]
    s_add_u32 m0, s16, 0
    s_add_u32 s58, s9, 57344
    v_mfma_f32_16x16x32_bf16 v[100:103], a[164:167], v[40:43], v[100:103]
    v_max3_u32 v10, v10, v228, v229
    v_max3_u32 v10, v10, v230, v231
    v_mfma_f32_16x16x32_bf16 v[100:103], a[180:183], v[44:47], v[100:103]
    buffer_load_dwordx4 v3, s[36:39], s58 offen lds
    v_mfma_f32_16x16x32_bf16 v[104:107], a[168:171], v[40:43], v[104:107]
    s_waitcnt lgkmcnt(6)
    v_max3_u32 v10, v10, v232, v233
    v_mfma_f32_16x16x32_bf16 v[104:107], a[184:187], v[44:47], v[104:107]
    v_max3_u32 v10, v10, v234, v235
    s_waitcnt lgkmcnt(5)
    v_mfma_f32_16x16x32_bf16 v[108:111], a[172:175], v[40:43], v[108:111]
    v_max3_u32 v10, v10, v236, v237
    v_max3_u32 v10, v10, v238, v239
    v_mfma_f32_16x16x32_bf16 v[108:111], a[188:191], v[44:47], v[108:111]
    s_waitcnt lgkmcnt(4)
    s_waitcnt lgkmcnt(0)
    v_mfma_f32_16x16x32_bf16 v[80:83], a[192:195], v[32:35], v[80:83]
    ds_read_b128 v[40:43], v14 offset:43264
    ds_read_b128 v[44:47], v15 offset:43392
    v_mfma_f32_16x16x32_bf16 v[80:83], a[208:211], v[36:39], v[80:83]
    buffer_load_dwordx4 v28, s[36:39], s58 offen offset:1024 lds
    v_mfma_f32_16x16x32_bf16 v[84:87], a[196:199], v[32:35], v[84:87]
    v_mov_b32 v8, s56
    s_waitcnt vmcnt(11)
    v_mfma_f32_16x16x32_bf16 v[84:87], a[212:215], v[36:39], v[84:87]
    v_max3_u32 v10, v10, v240, v241
    v_max3_u32 v10, v10, v242, v243
    v_mfma_f32_16x16x32_bf16 v[88:91], a[200:203], v[32:35], v[88:91]
    v_max3_u32 v10, v10, v244, v245
    v_max3_u32 v10, v10, v246, v247
    v_mfma_f32_16x16x32_bf16 v[88:91], a[216:219], v[36:39], v[88:91]
    v_max3_u32 v10, v10, v248, v249
    v_max3_u32 v10, v10, v250, v251
    v_mfma_f32_16x16x32_bf16 v[92:95], a[204:207], v[32:35], v[92:95]
    s_mov_b64 exec, 1
    buffer_store_dwordx2 v[6:7], v8, s[4:7], 0 offen sc1
    s_mov_b64 exec, -1
    v_mfma_f32_16x16x32_bf16 v[92:95], a[220:223], v[36:39], v[92:95]
    s_add_u32 m0, s16, 2048
    s_waitcnt lgkmcnt(0)
    v_mfma_f32_16x16x32_bf16 v[96:99], a[192:195], v[40:43], v[96:99]
    v_cmp_eq_u32 vcc, -1, v10
    s_cbranch_vccnz L_h2_retry
L_h2_ok:
    s_barrier
    ds_read_b128 v[32:35], v12 offset:0
    ds_read_b128 v[36:39], v13 offset:0
    v_mfma_f32_16x16x32_bf16 v[96:99], a[208:211], v[44:47], v[96:99]
    s_add_u32 s58, s9, 71680
    ds_read_b64_tr_b16 v[158:159], v0 offset:6688
    v_mfma_f32_16x16x32_bf16 v[100:103], a[196:199], v[40:43], v[100:103]
    buffer_load_dwordx4 v3, s[36:39], s58 offen lds
    v_mfma_f32_16x16x32_bf16 v[100:103], a[212:215], v[44:47], v[100:103]
    ds_read_b64_tr_b16 v[160:161], v0 offset:8192
    ds_read_b64_tr_b16 v[162:163], v0 offset:10240
    v_mfma_f32_16x16x32_bf16 v[104:107], a[200:203], v[40:43], v[104:107]
    ds_read_b64_tr_b16 v[164:165], v0 offset:8224
    ds_read_b64_tr_b16 v[166:167], v0 offset:10272
    v_mfma_f32_16x16x32_bf16 v[104:107], a[216:219], v[44:47], v[104:107]
    ds_read_b64_tr_b16 v[168:169], v0 offset:8704
    ds_read_b64_tr_b16 v[170:171], v0 offset:10752
    v_mfma_f32_16x16x32_bf16 v[108:111], a[204:207], v[40:43], v[108:111]
    buffer_load_dwordx4 v28, s[36:39], s58 offen offset:1024 lds
    v_mfma_f32_16x16x32_bf16 v[108:111], a[220:223], v[44:47], v[108:111]
    s_add_u32 m0, s63, 28672
    s_waitcnt lgkmcnt(7)
    v_mfma_f32_16x16x32_bf16 v[48:51], a[0:3], v[32:35], 0
    ds_read_b128 v[40:43], v12 offset:14336
    ds_read_b128 v[44:47], v13 offset:14336
    v_mfma_f32_16x16x32_bf16 v[48:51], a[16:19], v[36:39], v[48:51]
    s_add_u32 s57, s62, 86016
    ds_read_b64_tr_b16 v[172:173], v0 offset:8736
    v_mfma_f32_16x16x32_bf16 v[52:55], a[4:7], v[32:35], 0
    buffer_load_dwordx4 v11, s[4:7], s57 offen offset:0 sc1 lds
    v_mfma_f32_16x16x32_bf16 v[52:55], a[20:23], v[36:39], v[52:55]
    ds_read_b64_tr_b16 v[174:175], v0 offset:10784
    v_mfma_f32_16x16x32_bf16 v[56:59], a[8:11], v[32:35], 0
    v_mfma_f32_16x16x32_bf16 v[56:59], a[24:27], v[36:39], v[56:59]
    v_mfma_f32_16x16x32_bf16 v[60:63], a[12:15], v[32:35], 0
    buffer_load_dwordx4 v11, s[4:7], s57 offen offset:1024 sc1 lds
    v_mfma_f32_16x16x32_bf16 v[60:63], a[28:31], v[36:39], v[60:63]
    v_mul_f32 v80, v80, v88
    s_waitcnt lgkmcnt(2)
    v_mfma_f32_16x16x32_bf16 v[64:67], a[0:3], v[40:43], 0
    ds_read_b128 v[32:35], v12 offset:128
    ds_read_b128 v[36:39], v13 offset:128
    v_mfma_f32_16x16x32_bf16 v[64:67], a[16:19], v[44:47], v[64:67]
    v_mul_f32 v81, v81, v89
    v_mul_f32 v82, v82, v90
    v_mfma_f32_16x16x32_bf16 v[68:71], a[4:7], v[40:43], 0
    buffer_load_dwordx4 v11, s[4:7], s57 offen offset:2048 sc1 lds
    v_mfma_f32_16x16x32_bf16 v[68:71], a[20:23], v[44:47], v[68:71]
    v_mul_f32 v83, v83, v91
    v_mul_f32 v84, v84, v92
    v_mfma_f32_16x16x32_bf16 v[72:75], a[8:11], v[40:43], 0
    v_mul_f32 v85, v85, v93
    v_mul_f32 v86, v86, v94
    v_mfma_f32_16x16x32_bf16 v[72:75], a[24:27], v[44:47], v[72:75]
    v_mfma_f32_16x16x32_bf16 v[76:79], a[12:15], v[40:43], 0
    buffer_load_dwordx4 v11, s[4:7], s57 offen offset:3072 sc1 lds
    v_mfma_f32_16x16x32_bf16 v[76:79], a[28:31], v[44:47], v[76:79]
L_pg4:
    s_cbranch_execz L_warm
    s_add_u32 m0, s63, 32768
    s_waitcnt lgkmcnt(0)
    v_mfma_f32_16x16x32_bf16 v[48:51], a[32:35], v[32:35], v[48:51]
    ds_read_b128 v[40:43], v12 offset:14464
    ds_read_b128 v[44:47], v13 offset:14464
    v_mfma_f32_16x16x32_bf16 v[48:51], a[48:51], v[36:39], v[48:51]
    s_add_u32 s57, s62, 90112
    v_mul_f32 v87, v87, v95
    v_mfma_f32_16x16x32_bf16 v[52:55], a[36:39], v[32:35], v[52:55]
    buffer_load_dwordx4 v11, s[4:7], s57 offen offset:0 sc1 lds
    v_mfma_f32_16x16x32_bf16 v[52:55], a[52:55], v[36:39], v[52:55]
    v_cvt_pk_bf16_f32 v88, v80, v81
    v_cvt_pk_bf16_f32 v89, v82, v83
    v_mfma_f32_16x16x32_bf16 v[56:59], a[40:43], v[32:35], v[56:59]
    v_cvt_pk_bf16_f32 v90, v84, v85
    v_cvt_pk_bf16_f32 v91, v86, v87
    v_mfma_f32_16x16x32_bf16 v[56:59], a[56:59], v[36:39], v[56:59]
    v_mul_f32 v96, v96, v104
    v_mfma_f32_16x16x32_bf16 v[60:63], a[44:47], v[32:35], v[60:63]
    buffer_load_dwordx4 v11, s[4:7], s57 offen offset:1024 sc1 lds
    v_mfma_f32_16x16x32_bf16 v[60:63], a[60:63], v[36:39], v[60:63]
    v_mul_f32 v97, v97, v105
    s_waitcnt lgkmcnt(0)
    v_mfma_f32_16x16x32_bf16 v[64:67], a[32:35], v[40:43], v[64:67]
    ds_read_b128 v[32:35], v12 offset:256
    ds_read_b128 v[36:39], v13 offset:256
    v_mfma_f32_16x16x32_bf16 v[64:67], a[48:51], v[44:47], v[64:67]
    v_mul_f32 v98, v98, v106
    v_mul_f32 v99, v99, v107
    v_mfma_f32_16x16x32_bf16 v[68:71], a[36:39], v[40:43], v[68:71]
    v_mul_f32 v100, v100, v108
    v_mul_f32 v101, v101, v109
    v_mfma_f32_16x16x32_bf16 v[68:71], a[52:55], v[44:47], v[68:71]
    buffer_load_dwordx4 v11, s[4:7], s57 offen offset:2048 sc1 lds
    v_mfma_f32_16x16x32_bf16 v[72:75], a[40:43], v[40:43], v[72:75]
    v_mul_f32 v102, v102, v110
    ds_read_b64_tr_b16 v[176:177], v23 offset:0
    v_mfma_f32_16x16x32_bf16 v[72:75], a[56:59], v[44:47], v[72:75]
    s_add_u32 s59, s61, 114688
    v_mul_f32 v103, v103, v111
    v_mfma_f32_16x16x32_bf16 v[76:79], a[44:47], v[40:43], v[76:79]
    v_cvt_pk_bf16_f32 v104, v96, v97
    ds_read_b64_tr_b16 v[178:179], v23 offset:2048
    v_mfma_f32_16x16x32_bf16 v[76:79], a[60:63], v[44:47], v[76:79]
    v_cvt_pk_bf16_f32 v105, v98, v99
    s_waitcnt lgkmcnt(2)
    v_mfma_f32_16x16x32_bf16 v[48:51], a[64:67], v[32:35], v[48:51]
    ds_read_b128 v[40:43], v12 offset:14592
    ds_read_b128 v[44:47], v13 offset:14592
    v_mfma_f32_16x16x32_bf16 v[48:51], a[80:83], v[36:39], v[48:51]
    buffer_store_dwordx4 v[88:91], v11, s[4:7], s59 offen sc1
    v_mfma_f32_16x16x32_bf16 v[52:55], a[68:71], v[32:35], v[52:55]
    v_cvt_pk_bf16_f32 v106, v100, v101
    v_cvt_pk_bf16_f32 v107, v102, v103
    v_mfma_f32_16x16x32_bf16 v[52:55], a[84:87], v[36:39], v[52:55]
    s_add_u32 s59, s61, 172032
    ds_read_b64_tr_b16 v[180:181], v23 offset:32
    v_mfma_f32_16x16x32_bf16 v[56:59], a[72:75], v[32:35], v[56:59]
    ds_read_b64_tr_b16 v[182:183], v23 offset:2080
    ds_read_b64_tr_b16 v[184:185], v23 offset:512
    v_mfma_f32_16x16x32_bf16 v[56:59], a[88:91], v[36:39], v[56:59]
    ds_read_b64_tr_b16 v[186:187], v23 offset:2560
    ds_read_b64_tr_b16 v[188:189], v23 offset:544
    v_mfma_f32_16x16x32_bf16 v[60:63], a[76:79], v[32:35], v[60:63]
    buffer_store_dwordx4 v[104:107], v11, s[4:7], s59 offen sc1
    v_mfma_f32_16x16x32_bf16 v[60:63], a[92:95], v[36:39], v[60:63]
    s_add_u32 m0, s16, 4096
    s_waitcnt lgkmcnt(5)
    v_mfma_f32_16x16x32_bf16 v[64:67], a[64:67], v[40:43], v[64:67]
    ds_read_b128 v[32:35], v12 offset:384
    ds_read_b128 v[36:39], v15 offset:0
    v_mfma_f32_16x16x32_bf16 v[64:67], a[80:83], v[44:47], v[64:67]
    s_add_u32 s58, s9, 86016
    ds_read_b64_tr_b16 v[190:191], v23 offset:2592
    v_mfma_f32_16x16x32_bf16 v[68:71], a[68:71], v[40:43], v[68:71]
    buffer_load_dwordx4 v3, s[36:39], s58 offen lds
    v_mfma_f32_16x16x32_bf16 v[68:71], a[84:87], v[44:47], v[68:71]
    v_mfma_f32_16x16x32_bf16 v[72:75], a[72:75], v[40:43], v[72:75]
    v_mfma_f32_16x16x32_bf16 v[72:75], a[88:91], v[44:47], v[72:75]
    v_mfma_f32_16x16x32_bf16 v[76:79], a[76:79], v[40:43], v[76:79]
    v_mfma_f32_16x16x32_bf16 v[76:79], a[92:95], v[44:47], v[76:79]
    s_waitcnt lgkmcnt(1)
    v_mfma_f32_16x16x32_bf16 v[48:51], a[96:99], v[32:35], v[48:51]
    buffer_load_dwordx4 v28, s[36:39], s58 offen offset:1024 lds
    ds_read_b128 v[40:43], v12 offset:14720
    ds_read_b128 v[44:47], v15 offset:14336
    v_mfma_f32_16x16x32_bf16 v[48:51], a[112:115], v[36:39], v[48:51]
    v_mfma_f32_16x16x32_bf16 v[52:55], a[100:103], v[32:35], v[52:55]
    v_mfma_f32_16x16x32_bf16 v[52:55], a[116:119], v[36:39], v[52:55]
    v_mfma_f32_16x16x32_bf16 v[56:59], a[104:107], v[32:35], v[56:59]
    buffer_load_dwordx2 v[20:21], v9, s[4:7], 0 offen sc1
    v_mfma_f32_16x16x32_bf16 v[56:59], a[120:123], v[36:39], v[56:59]
    v_mfma_f32_16x16x32_bf16 v[60:63], a[108:111], v[32:35], v[60:63]
    s_add_u32 m0, s16, 6144
    s_add_u32 s58, s9, 100352
    v_mfma_f32_16x16x32_bf16 v[60:63], a[124:127], v[36:39], v[60:63]
    s_waitcnt vmcnt(21)
    s_waitcnt lgkmcnt(0)
    v_mfma_f32_16x16x32_bf16 v[64:67], a[96:99], v[40:43], v[64:67]
    ds_read_b128 v[32:35], v14 offset:0
    ds_read_b128 v[36:39], v15 offset:128
    v_mfma_f32_16x16x32_bf16 v[64:67], a[112:115], v[44:47], v[64:67]
    buffer_load_dwordx4 v3, s[36:39], s58 offen lds
    v_mfma_f32_16x16x32_bf16 v[68:71], a[100:103], v[40:43], v[68:71]
    ds_read_b64_tr_b16 v[192:193], v23 offset:4096
    ds_read_b64_tr_b16 v[194:195], v23 offset:6144
    v_mfma_f32_16x16x32_bf16 v[68:71], a[116:119], v[44:47], v[68:71]
    ds_read_b64_tr_b16 v[196:197], v23 offset:4128
    ds_read_b64_tr_b16 v[198:199], v23 offset:6176
    v_mfma_f32_16x16x32_bf16 v[72:75], a[104:107], v[40:43], v[72:75]
    ds_read_b64_tr_b16 v[200:201], v23 offset:4608
    ds_read_b64_tr_b16 v[202:203], v23 offset:6656
    v_mfma_f32_16x16x32_bf16 v[72:75], a[120:123], v[44:47], v[72:75]
    ds_read_b64_tr_b16 v[204:205], v23 offset:4640
    ds_read_b64_tr_b16 v[206:207], v23 offset:6688
    v_mfma_f32_16x16x32_bf16 v[76:79], a[108:111], v[40:43], v[76:79]
    buffer_load_dwordx4 v28, s[36:39], s58 offen offset:1024 lds
    v_mfma_f32_16x16x32_bf16 v[76:79], a[124:127], v[44:47], v[76:79]
    s_waitcnt vmcnt(19)
    s_waitcnt lgkmcnt(8)
    v_mfma_f32_16x16x32_bf16 v[48:51], a[128:131], v[32:35], v[48:51]
    ds_read_b128 v[40:43], v14 offset:14336
    ds_read_b128 v[44:47], v15 offset:14464
    v_mfma_f32_16x16x32_bf16 v[48:51], a[144:147], v[36:39], v[48:51]
    s_add_u32 m0, s16, 8192
    s_add_u32 s58, s9, 114688
    v_mfma_f32_16x16x32_bf16 v[52:55], a[132:135], v[32:35], v[52:55]
    ds_read_b64_tr_b16 v[208:209], v23 offset:8192
    ds_read_b64_tr_b16 v[210:211], v23 offset:10240
    v_mfma_f32_16x16x32_bf16 v[52:55], a[148:151], v[36:39], v[52:55]
    buffer_load_dwordx4 v3, s[36:39], s58 offen lds
    v_mfma_f32_16x16x32_bf16 v[56:59], a[136:139], v[32:35], v[56:59]
    ds_read_b64_tr_b16 v[212:213], v23 offset:8224
    ds_read_b64_tr_b16 v[214:215], v23 offset:10272
    v_mfma_f32_16x16x32_bf16 v[56:59], a[152:155], v[36:39], v[56:59]
    ds_read_b64_tr_b16 v[216:217], v23 offset:8704
    ds_read_b64_tr_b16 v[218:219], v23 offset:10752
    v_mfma_f32_16x16x32_bf16 v[60:63], a[140:143], v[32:35], v[60:63]
    ds_read_b64_tr_b16 v[220:221], v23 offset:8736
    ds_read_b64_tr_b16 v[222:223], v23 offset:10784
    v_mfma_f32_16x16x32_bf16 v[60:63], a[156:159], v[36:39], v[60:63]
    s_waitcnt lgkmcnt(8)
    v_mfma_f32_16x16x32_bf16 v[64:67], a[128:131], v[40:43], v[64:67]
    ds_read_b128 v[32:35], v14 offset:128
    ds_read_b128 v[36:39], v15 offset:256
    v_mfma_f32_16x16x32_bf16 v[64:67], a[144:147], v[44:47], v[64:67]
    buffer_load_dwordx4 v28, s[36:39], s58 offen offset:1024 lds
    v_mfma_f32_16x16x32_bf16 v[68:71], a[132:135], v[40:43], v[68:71]
    s_add_u32 m0, s16, 10240
    s_add_u32 s58, s9, 129024
    v_mfma_f32_16x16x32_bf16 v[68:71], a[148:151], v[44:47], v[68:71]
    v_mfma_f32_16x16x32_bf16 v[72:75], a[136:139], v[40:43], v[72:75]
    s_waitcnt vmcnt(9)
    ds_read_b128 v[224:227], v2 offset:28672
    v_mfma_f32_16x16x32_bf16 v[72:75], a[152:155], v[44:47], v[72:75]
    buffer_load_dwordx4 v3, s[36:39], s58 offen lds
    v_mfma_f32_16x16x32_bf16 v[76:79], a[140:143], v[40:43], v[76:79]
    ds_read_b128 v[228:231], v2 offset:29696
    ds_read_b128 v[232:235], v2 offset:30720
    v_mfma_f32_16x16x32_bf16 v[76:79], a[156:159], v[44:47], v[76:79]
    ds_read_b128 v[236:239], v2 offset:31744
    s_waitcnt lgkmcnt(4)
    v_mfma_f32_16x16x32_bf16 v[48:51], a[160:163], v[32:35], v[48:51]
    ds_read_b128 v[40:43], v14 offset:14464
    ds_read_b128 v[44:47], v15 offset:14592
    v_mfma_f32_16x16x32_bf16 v[48:51], a[176:179], v[36:39], v[48:51]
    ds_read_b128 v[240:243], v2 offset:32768
    ds_read_b128 v[244:247], v2 offset:33792
    v_mfma_f32_16x16x32_bf16 v[52:55], a[164:167], v[32:35], v[52:55]
    buffer_load_dwordx4 v28, s[36:39], s58 offen offset:1024 lds
    v_mfma_f32_16x16x32_bf16 v[52:55], a[180:183], v[36:39], v[52:55]
    ds_read_b128 v[248:251], v2 offset:34816
    s_waitcnt lgkmcnt(8)
    v_mfma_f32_16x16x32_bf16 v[56:59], a[168:171], v[32:35], v[56:59]
    s_add_u32 m0, s64, 0
    s_add_u32 s58, s9, 143360
    v_mfma_f32_16x16x32_bf16 v[56:59], a[184:187], v[36:39], v[56:59]
    v_max3_u32 v10, v224, v225, v226
    v_max_u32 v10, v10, v227
    v_mfma_f32_16x16x32_bf16 v[60:63], a[172:175], v[32:35], v[60:63]
    s_waitcnt lgkmcnt(7)
    v_max3_u32 v10, v10, v228, v229
    v_mfma_f32_16x16x32_bf16 v[60:63], a[188:191], v[36:39], v[60:63]
    v_max3_u32 v10, v10, v230, v231
    s_waitcnt lgkmcnt(3)
    v_mfma_f32_16x16x32_bf16 v[64:67], a[160:163], v[40:43], v[64:67]
    buffer_load_dwordx4 v3, s[36:39], s58 offen lds
    ds_read_b128 v[32:35], v14 offset:256
    ds_read_b128 v[36:39], v15 offset:384
    v_mfma_f32_16x16x32_bf16 v[64:67], a[176:179], v[44:47], v[64:67]
    v_max3_u32 v10, v10, v232, v233
    v_max3_u32 v10, v10, v234, v235
    v_mfma_f32_16x16x32_bf16 v[68:71], a[164:167], v[40:43], v[68:71]
    v_max3_u32 v10, v10, v236, v237
    v_max3_u32 v10, v10, v238, v239
    v_mfma_f32_16x16x32_bf16 v[68:71], a[180:183], v[44:47], v[68:71]
    s_waitcnt lgkmcnt(4)
    v_max3_u32 v10, v10, v240, v241
    v_mfma_f32_16x16x32_bf16 v[72:75], a[168:171], v[40:43], v[72:75]
    buffer_load_dwordx4 v28, s[36:39], s58 offen offset:1024 lds
    v_mfma_f32_16x16x32_bf16 v[72:75], a[184:187], v[44:47], v[72:75]
    v_max3_u32 v10, v10, v242, v243
    s_waitcnt lgkmcnt(3)
    v_mfma_f32_16x16x32_bf16 v[76:79], a[172:175], v[40:43], v[76:79]
    s_add_u32 m0, s64, 2048
    s_add_u32 s58, s9, 157696
    v_mfma_f32_16x16x32_bf16 v[76:79], a[188:191], v[44:47], v[76:79]
    v_max3_u32 v10, v10, v244, v245
    s_waitcnt lgkmcnt(0)
    v_mfma_f32_16x16x32_bf16 v[48:51], a[192:195], v[32:35], v[48:51]
    ds_read_b128 v[40:43], v14 offset:14592
    ds_read_b128 v[44:47], v15 offset:14720
    v_mfma_f32_16x16x32_bf16 v[48:51], a[208:211], v[36:39], v[48:51]
    buffer_load_dwordx4 v3, s[36:39], s58 offen lds
    v_mfma_f32_16x16x32_bf16 v[52:55], a[196:199], v[32:35], v[52:55]
    v_max3_u32 v10, v10, v246, v247
    v_max3_u32 v10, v10, v248, v249
    v_mfma_f32_16x16x32_bf16 v[52:55], a[212:215], v[36:39], v[52:55]
    v_max3_u32 v10, v10, v250, v251
    s_waitcnt vmcnt(9)
    v_mfma_f32_16x16x32_bf16 v[56:59], a[200:203], v[32:35], v[56:59]
    v_cmp_ne_u64 vcc, s[50:51], v[20:21]
    s_cbranch_vccnz L_fc_retry
L_fc_ok:
    v_mfma_f32_16x16x32_bf16 v[56:59], a[216:219], v[36:39], v[56:59]
    v_lshrrev_b32 v16, 3, v1
    v_and_b32 v17, 7, v1
    v_mfma_f32_16x16x32_bf16 v[60:63], a[204:207], v[32:35], v[60:63]
    buffer_load_dwordx4 v28, s[36:39], s58 offen offset:1024 lds
    v_mfma_f32_16x16x32_bf16 v[60:63], a[220:223], v[36:39], v[60:63]
    v_mul_u32_u24 v18, 896, v16
    s_waitcnt lgkmcnt(0)
    v_mfma_f32_16x16x32_bf16 v[64:67], a[192:195], v[40:43], v[64:67]
    v_cmp_eq_u32 vcc, -1, v10
    s_cbranch_vccnz L_h3_retry
L_h3_ok:
    s_barrier
    ds_read_b128 v[32:35], v12 offset:28672
    ds_read_b128 v[36:39], v13 offset:28672
    v_mfma_f32_16x16x32_bf16 v[64:67], a[208:211], v[44:47], v[64:67]
    v_lshl_add_u32 v18, v17, 4, v18
    v_lshlrev_b32 v22, 4, v17
    v_mfma_f32_16x16x32_bf16 v[68:71], a[196:199], v[40:43], v[68:71]
    s_lshl_b32 s49, s14, 7
    s_add_u32 s49, s49, 70016
    v_mfma_f32_16x16x32_bf16 v[68:71], a[212:215], v[44:47], v[68:71]
    s_add_u32 s45, s48, 8388608
    s_add_u32 s47, s45, 57344
    v_mfma_f32_16x16x32_bf16 v[72:75], a[200:203], v[40:43], v[72:75]
    s_mov_b64 exec, 1
    buffer_store_dwordx2 v[6:7], v8, s[4:7], 0 offen offset:8 sc1
    s_mov_b64 exec, -1
    v_mfma_f32_16x16x32_bf16 v[72:75], a[216:219], v[44:47], v[72:75]
    s_add_u32 m0, s64, 4096
    s_add_u32 s58, s9, 172032
    v_mfma_f32_16x16x32_bf16 v[76:79], a[204:207], v[40:43], v[76:79]
    v_and_b32 v19, 15, v1
    ds_read_b64_tr_b16 v[224:225], v0 offset:0
    v_mfma_f32_16x16x32_bf16 v[76:79], a[220:223], v[44:47], v[76:79]
    ds_read_b64_tr_b16 v[226:227], v0 offset:2048
    s_waitcnt lgkmcnt(2)
    v_mfma_f32_16x16x32_bf16 v[80:83], a[0:3], v[32:35], 0
    buffer_load_dwordx4 v3, s[36:39], s58 offen lds
    ds_read_b128 v[40:43], v12 offset:43008
    ds_read_b128 v[44:47], v13 offset:43008
    v_mfma_f32_16x16x32_bf16 v[80:83], a[16:19], v[36:39], v[80:83]
    ds_read_b64_tr_b16 v[228:229], v0 offset:32
    ds_read_b64_tr_b16 v[230:231], v0 offset:2080
    v_mfma_f32_16x16x32_bf16 v[84:87], a[4:7], v[32:35], 0
    ds_read_b64_tr_b16 v[232:233], v0 offset:512
    ds_read_b64_tr_b16 v[234:235], v0 offset:2560
    v_mfma_f32_16x16x32_bf16 v[84:87], a[20:23], v[36:39], v[84:87]
    buffer_load_dwordx4 v28, s[36:39], s58 offen offset:1024 lds
    v_mfma_f32_16x16x32_bf16 v[88:91], a[8:11], v[32:35], 0
    s_add_u32 m0, s64, 6144
    s_add_u32 s58, s9, 186368
    v_mfma_f32_16x16x32_bf16 v[88:91], a[24:27], v[36:39], v[88:91]
    ds_read_b64_tr_b16 v[236:237], v0 offset:544
    ds_read_b64_tr_b16 v[238:239], v0 offset:2592
    v_mfma_f32_16x16x32_bf16 v[92:95], a[12:15], v[32:35], 0
    v_mul_f32 v48, v48, v56
    v_mfma_f32_16x16x32_bf16 v[92:95], a[28:31], v[36:39], v[92:95]
    v_mul_f32 v49, v49, v57
    s_waitcnt lgkmcnt(6)
    v_mfma_f32_16x16x32_bf16 v[96:99], a[0:3], v[40:43], 0
    buffer_load_dwordx4 v3, s[36:39], s58 offen lds
    ds_read_b128 v[32:35], v12 offset:28800
    ds_read_b128 v[36:39], v13 offset:28800
    v_mfma_f32_16x16x32_bf16 v[96:99], a[16:19], v[44:47], v[96:99]
    v_mul_f32 v50, v50, v58
    v_mfma_f32_16x16x32_bf16 v[100:103], a[4:7], v[40:43], 0
    v_mul_f32 v51, v51, v59
    s_waitcnt vmcnt(12)
    v_mfma_f32_16x16x32_bf16 v[100:103], a[20:23], v[44:47], v[100:103]
    buffer_load_dwordx4 v28, s[36:39], s58 offen offset:1024 lds
    v_mfma_f32_16x16x32_bf16 v[104:107], a[8:11], v[40:43], 0
    v_mul_f32 v52, v52, v60
    s_lshl_b32 s62, s46, 4
    v_mfma_f32_16x16x32_bf16 v[104:107], a[24:27], v[44:47], v[104:107]
    s_mul_i32 s63, s3, 14
    s_add_u32 s62, s62, s63
    v_mfma_f32_16x16x32_bf16 v[108:111], a[12:15], v[40:43], 0
    v_mul_f32 v53, v53, v61
    s_lshl_b32 s62, s62, 5
    v_mfma_f32_16x16x32_bf16 v[108:111], a[28:31], v[44:47], v[108:111]
    v_mul_f32 v54, v54, v62
    s_waitcnt lgkmcnt(0)
    v_mfma_f32_16x16x32_bf16 v[80:83], a[32:35], v[32:35], v[80:83]
    buffer_load_dwordx4 v[24:27], v18, s[4:7], s45 offen sc1
    ds_read_b128 v[40:43], v12 offset:43136
    ds_read_b128 v[44:47], v13 offset:43136
    v_mfma_f32_16x16x32_bf16 v[80:83], a[48:51], v[36:39], v[80:83]
    s_add_u32 s60, s65, 0
    v_mul_f32 v55, v55, v63
    v_mfma_f32_16x16x32_bf16 v[84:87], a[36:39], v[32:35], v[84:87]
    v_cvt_pk_bf16_f32 v56, v48, v49
    s_add_u32 s62, s62, 131072
    v_mfma_f32_16x16x32_bf16 v[84:87], a[52:55], v[36:39], v[84:87]
    v_min_u32 v3, 13, v1
    v_lshl_add_u32 v3, v3, 5, s62
    v_mfma_f32_16x16x32_bf16 v[88:91], a[40:43], v[32:35], v[88:91]
    buffer_load_dwordx4 a[0:3], v11, s[4:7], s60 offen offset:0 sc1
    v_mfma_f32_16x16x32_bf16 v[88:91], a[56:59], v[36:39], v[88:91]
    v_cvt_pk_bf16_f32 v57, v50, v51
    ds_read_b64_tr_b16 v[240:241], v0 offset:4096
    v_mfma_f32_16x16x32_bf16 v[92:95], a[44:47], v[32:35], v[92:95]
    v_cvt_pk_bf16_f32 v58, v52, v53
    ds_read_b64_tr_b16 v[242:243], v0 offset:6144
    v_mfma_f32_16x16x32_bf16 v[92:95], a[60:63], v[36:39], v[92:95]
    v_cvt_pk_bf16_f32 v59, v54, v55
    s_waitcnt lgkmcnt(2)
    v_mfma_f32_16x16x32_bf16 v[96:99], a[32:35], v[40:43], v[96:99]
    ds_read_b128 v[32:35], v12 offset:28928
    ds_read_b128 v[36:39], v13 offset:28928
    v_mfma_f32_16x16x32_bf16 v[96:99], a[48:51], v[44:47], v[96:99]
    buffer_load_dwordx4 a[4:7], v11, s[4:7], s60 offen offset:1024 sc1
    v_mfma_f32_16x16x32_bf16 v[100:103], a[36:39], v[40:43], v[100:103]
    s_add_u32 s59, s61, 229376
    ds_read_b64_tr_b16 v[244:245], v0 offset:4128
    v_mfma_f32_16x16x32_bf16 v[100:103], a[52:55], v[44:47], v[100:103]
    v_mul_f32 v64, v64, v72
    ds_read_b64_tr_b16 v[246:247], v0 offset:6176
    v_mfma_f32_16x16x32_bf16 v[104:107], a[40:43], v[40:43], v[104:107]
    v_mul_f32 v65, v65, v73
    ds_read_b64_tr_b16 v[248:249], v0 offset:4608
    v_mfma_f32_16x16x32_bf16 v[104:107], a[56:59], v[44:47], v[104:107]
    buffer_store_dwordx4 v[56:59], v11, s[4:7], s59 offen sc1
    v_mfma_f32_16x16x32_bf16 v[108:111], a[44:47], v[40:43], v[108:111]
    v_mul_f32 v66, v66, v74
    ds_read_b64_tr_b16 v[250:251], v0 offset:6656
    v_mfma_f32_16x16x32_bf16 v[108:111], a[60:63], v[44:47], v[108:111]
    v_mul_f32 v67, v67, v75
    s_waitcnt lgkmcnt(4)
    v_mfma_f32_16x16x32_bf16 v[80:83], a[64:67], v[32:35], v[80:83]
    ds_read_b128 v[40:43], v12 offset:43264
    ds_read_b128 v[44:47], v13 offset:43264
    v_mfma_f32_16x16x32_bf16 v[80:83], a[80:83], v[36:39], v[80:83]
    buffer_load_dwordx4 a[8:11], v11, s[4:7], s60 offen offset:2048 sc1
    v_mfma_f32_16x16x32_bf16 v[84:87], a[68:71], v[32:35], v[84:87]
    v_mul_f32 v68, v68, v76
    ds_read_b64_tr_b16 v[252:253], v0 offset:4640
    v_mfma_f32_16x16x32_bf16 v[84:87], a[84:87], v[36:39], v[84:87]
    v_mul_f32 v69, v69, v77
    ds_read_b64_tr_b16 v[254:255], v0 offset:6688
    v_mfma_f32_16x16x32_bf16 v[88:91], a[72:75], v[32:35], v[88:91]
    buffer_load_dwordx4 a[12:15], v11, s[4:7], s60 offen offset:3072 sc1
    v_mfma_f32_16x16x32_bf16 v[88:91], a[88:91], v[36:39], v[88:91]
    v_mul_f32 v70, v70, v78
    v_mul_u32_u24 v2, 272, v19
    v_mfma_f32_16x16x32_bf16 v[92:95], a[76:79], v[32:35], v[92:95]
    v_mul_f32 v71, v71, v79
    v_lshrrev_b32 v5, 4, v1
    v_mfma_f32_16x16x32_bf16 v[92:95], a[92:95], v[36:39], v[92:95]
    v_cvt_pk_bf16_f32 v72, v64, v65
    s_waitcnt lgkmcnt(2)
    v_mfma_f32_16x16x32_bf16 v[96:99], a[64:67], v[40:43], v[96:99]
    ds_read_b128 v[32:35], v12 offset:29056
    ds_read_b128 v[36:39], v15 offset:28672
    v_mfma_f32_16x16x32_bf16 v[96:99], a[80:83], v[44:47], v[96:99]
    buffer_load_dwordx2 v[20:21], v3, s[4:7], 0 offen offset:8 sc1
    v_mfma_f32_16x16x32_bf16 v[100:103], a[68:71], v[40:43], v[100:103]
    s_add_u32 s60, s65, 4096
    v_cvt_pk_bf16_f32 v73, v66, v67
    v_mfma_f32_16x16x32_bf16 v[100:103], a[84:87], v[44:47], v[100:103]
    v_cvt_pk_bf16_f32 v74, v68, v69
    v_lshl_add_u32 v2, v5, 4, v2
    v_mfma_f32_16x16x32_bf16 v[104:107], a[72:75], v[40:43], v[104:107]
    v_cvt_pk_bf16_f32 v75, v70, v71
    s_mul_i32 s62, s3, 4352
    v_mfma_f32_16x16x32_bf16 v[104:107], a[88:91], v[44:47], v[104:107]
    buffer_load_dwordx4 a[16:19], v11, s[4:7], s60 offen offset:0 sc1
    v_mfma_f32_16x16x32_bf16 v[108:111], a[76:79], v[40:43], v[108:111]
    s_add_u32 s59, s61, 286720
    v_add_u32 v2, s62, v2
    v_mfma_f32_16x16x32_bf16 v[108:111], a[92:95], v[44:47], v[108:111]
    v_mul_u32_u24 v5, 272, v16
    s_waitcnt lgkmcnt(0)
    v_mfma_f32_16x16x32_bf16 v[80:83], a[96:99], v[32:35], v[80:83]
    ds_read_b128 v[40:43], v12 offset:43392
    ds_read_b128 v[44:47], v15 offset:43008
    v_mfma_f32_16x16x32_bf16 v[80:83], a[112:115], v[36:39], v[80:83]
    v_lshl_add_u32 v5, v17, 5, v5
    s_lshr_b32 s62, s3, 1
    v_mfma_f32_16x16x32_bf16 v[84:87], a[100:103], v[32:35], v[84:87]
    buffer_store_dwordx4 v[72:75], v11, s[4:7], s59 offen sc1
    v_mfma_f32_16x16x32_bf16 v[84:87], a[116:119], v[36:39], v[84:87]
    s_mul_i32 s63, s62, 17408
    v_add_u32 v5, s63, v5
    v_mfma_f32_16x16x32_bf16 v[88:91], a[104:107], v[32:35], v[88:91]
    s_mul_i32 s63, s62, 52224
    s_sub_u32 s63, 34816, s63
    v_mfma_f32_16x16x32_bf16 v[88:91], a[120:123], v[36:39], v[88:91]
    buffer_load_dwordx4 a[20:23], v11, s[4:7], s60 offen offset:1024 sc1
    v_mfma_f32_16x16x32_bf16 v[92:95], a[108:111], v[32:35], v[92:95]
    s_and_b32 s62, s3, 1
    s_mul_i32 s62, s62, 2176
    v_mfma_f32_16x16x32_bf16 v[92:95], a[124:127], v[36:39], v[92:95]
    v_add_u32 v5, s62, v5
    s_waitcnt lgkmcnt(0)
    v_mfma_f32_16x16x32_bf16 v[96:99], a[96:99], v[40:43], v[96:99]
    ds_read_b128 v[32:35], v14 offset:28672
    ds_read_b128 v[36:39], v15 offset:28800
    v_mfma_f32_16x16x32_bf16 v[96:99], a[112:115], v[44:47], v[96:99]
    buffer_load_dwordx4 a[24:27], v11, s[4:7], s60 offen offset:2048 sc1
    v_mfma_f32_16x16x32_bf16 v[100:103], a[100:103], v[40:43], v[100:103]
    v_mov_b32 v4, v18
    v_mfma_f32_16x16x32_bf16 v[100:103], a[116:119], v[44:47], v[100:103]
    v_mfma_f32_16x16x32_bf16 v[104:107], a[104:107], v[40:43], v[104:107]
    v_mfma_f32_16x16x32_bf16 v[104:107], a[120:123], v[44:47], v[104:107]
    v_mfma_f32_16x16x32_bf16 v[108:111], a[108:111], v[40:43], v[108:111]
    buffer_load_dwordx4 a[28:31], v11, s[4:7], s60 offen offset:3072 sc1
    v_mfma_f32_16x16x32_bf16 v[108:111], a[124:127], v[44:47], v[108:111]
    s_add_u32 s60, s65, 8192
    s_waitcnt lgkmcnt(0)
    v_mfma_f32_16x16x32_bf16 v[80:83], a[128:131], v[32:35], v[80:83]
    ds_read_b128 v[40:43], v14 offset:43008
    ds_read_b128 v[44:47], v15 offset:43136
    v_mfma_f32_16x16x32_bf16 v[80:83], a[144:147], v[36:39], v[80:83]
    v_mfma_f32_16x16x32_bf16 v[84:87], a[132:135], v[32:35], v[84:87]
    buffer_load_dwordx4 a[32:35], v11, s[4:7], s60 offen offset:0 sc1
    v_mfma_f32_16x16x32_bf16 v[84:87], a[148:151], v[36:39], v[84:87]
    v_mfma_f32_16x16x32_bf16 v[88:91], a[136:139], v[32:35], v[88:91]
    v_mfma_f32_16x16x32_bf16 v[88:91], a[152:155], v[36:39], v[88:91]
    v_mfma_f32_16x16x32_bf16 v[92:95], a[140:143], v[32:35], v[92:95]
    buffer_load_dwordx4 a[36:39], v11, s[4:7], s60 offen offset:1024 sc1
    v_mfma_f32_16x16x32_bf16 v[92:95], a[156:159], v[36:39], v[92:95]
    s_waitcnt lgkmcnt(0)
    v_mfma_f32_16x16x32_bf16 v[96:99], a[128:131], v[40:43], v[96:99]
    ds_read_b128 v[32:35], v14 offset:28800
    ds_read_b128 v[36:39], v15 offset:28928
    v_mfma_f32_16x16x32_bf16 v[96:99], a[144:147], v[44:47], v[96:99]
    v_mfma_f32_16x16x32_bf16 v[100:103], a[132:135], v[40:43], v[100:103]
    buffer_load_dwordx4 a[40:43], v11, s[4:7], s60 offen offset:2048 sc1
    v_mfma_f32_16x16x32_bf16 v[100:103], a[148:151], v[44:47], v[100:103]
    v_mfma_f32_16x16x32_bf16 v[104:107], a[136:139], v[40:43], v[104:107]
    v_mfma_f32_16x16x32_bf16 v[104:107], a[152:155], v[44:47], v[104:107]
    v_mfma_f32_16x16x32_bf16 v[108:111], a[140:143], v[40:43], v[108:111]
    buffer_load_dwordx4 a[44:47], v11, s[4:7], s60 offen offset:3072 sc1
    v_mfma_f32_16x16x32_bf16 v[108:111], a[156:159], v[44:47], v[108:111]
    s_waitcnt lgkmcnt(0)
    v_mfma_f32_16x16x32_bf16 v[80:83], a[160:163], v[32:35], v[80:83]
    ds_read_b128 v[40:43], v14 offset:43136
    ds_read_b128 v[44:47], v15 offset:43264
    v_mfma_f32_16x16x32_bf16 v[80:83], a[176:179], v[36:39], v[80:83]
    s_add_u32 s60, s65, 12288
    v_mfma_f32_16x16x32_bf16 v[84:87], a[164:167], v[32:35], v[84:87]
    v_mfma_f32_16x16x32_bf16 v[84:87], a[180:183], v[36:39], v[84:87]
    buffer_load_dwordx4 a[48:51], v11, s[4:7], s60 offen offset:0 sc1
    v_mfma_f32_16x16x32_bf16 v[88:91], a[168:171], v[32:35], v[88:91]
    v_mfma_f32_16x16x32_bf16 v[88:91], a[184:187], v[36:39], v[88:91]
    v_mfma_f32_16x16x32_bf16 v[92:95], a[172:175], v[32:35], v[92:95]
    s_waitcnt vmcnt(10)
    v_cmp_ne_u64 vcc, s[50:51], v[20:21]
    s_cbranch_vccnz L_ft1_retry
L_ft1_ok:
    v_mfma_f32_16x16x32_bf16 v[92:95], a[188:191], v[36:39], v[92:95]
    s_waitcnt lgkmcnt(0)
    v_mfma_f32_16x16x32_bf16 v[96:99], a[160:163], v[40:43], v[96:99]
    buffer_load_dwordx4 a[52:55], v11, s[4:7], s60 offen offset:1024 sc1
    ds_read_b128 v[32:35], v14 offset:28928
    ds_read_b128 v[36:39], v15 offset:29056
    v_mfma_f32_16x16x32_bf16 v[96:99], a[176:179], v[44:47], v[96:99]
    s_add_u32 s60, s65, 114688
    v_mfma_f32_16x16x32_bf16 v[100:103], a[164:167], v[40:43], v[100:103]
    v_mfma_f32_16x16x32_bf16 v[100:103], a[180:183], v[44:47], v[100:103]
    buffer_load_dwordx4 a[56:59], v11, s[4:7], s60 offen offset:0 sc1
    v_mfma_f32_16x16x32_bf16 v[104:107], a[168:171], v[40:43], v[104:107]
    v_mfma_f32_16x16x32_bf16 v[104:107], a[184:187], v[44:47], v[104:107]
    v_mfma_f32_16x16x32_bf16 v[108:111], a[172:175], v[40:43], v[108:111]
    v_mfma_f32_16x16x32_bf16 v[108:111], a[188:191], v[44:47], v[108:111]
    s_waitcnt lgkmcnt(0)
    v_mfma_f32_16x16x32_bf16 v[80:83], a[192:195], v[32:35], v[80:83]
    buffer_load_dwordx4 a[60:63], v11, s[4:7], s60 offen offset:1024 sc1
    ds_read_b128 v[40:43], v14 offset:43264
    ds_read_b128 v[44:47], v15 offset:43392
    v_mfma_f32_16x16x32_bf16 v[80:83], a[208:211], v[36:39], v[80:83]
    v_mfma_f32_16x16x32_bf16 v[84:87], a[196:199], v[32:35], v[84:87]
    ds_read_b64_tr_b16 a[168:169], v0 offset:8192
    v_mfma_f32_16x16x32_bf16 v[84:87], a[212:215], v[36:39], v[84:87]
    buffer_load_dwordx4 a[64:67], v11, s[4:7], s60 offen offset:2048 sc1
    v_mfma_f32_16x16x32_bf16 v[88:91], a[200:203], v[32:35], v[88:91]
    ds_read_b64_tr_b16 a[170:171], v0 offset:10240
    ds_read_b64_tr_b16 a[172:173], v0 offset:8224
    v_mfma_f32_16x16x32_bf16 v[88:91], a[216:219], v[36:39], v[88:91]
    ds_read_b64_tr_b16 a[174:175], v0 offset:10272
    v_mfma_f32_16x16x32_bf16 v[92:95], a[204:207], v[32:35], v[92:95]
    ds_read_b64_tr_b16 a[176:177], v0 offset:8704
    v_mfma_f32_16x16x32_bf16 v[92:95], a[220:223], v[36:39], v[92:95]
    ds_read_b64_tr_b16 a[178:179], v0 offset:10752
    s_waitcnt lgkmcnt(6)
    v_mfma_f32_16x16x32_bf16 v[96:99], a[192:195], v[40:43], v[96:99]
    buffer_load_dwordx4 a[68:71], v11, s[4:7], s60 offen offset:3072 sc1
    v_mfma_f32_16x16x32_bf16 v[96:99], a[208:211], v[44:47], v[96:99]
    s_add_u32 s60, s65, 118784
    ds_read_b64_tr_b16 a[180:181], v0 offset:8736
    v_mfma_f32_16x16x32_bf16 v[100:103], a[196:199], v[40:43], v[100:103]
    ds_read_b64_tr_b16 a[182:183], v0 offset:10784
    v_mfma_f32_16x16x32_bf16 v[100:103], a[212:215], v[44:47], v[100:103]
    v_mfma_f32_16x16x32_bf16 v[104:107], a[200:203], v[40:43], v[104:107]
    buffer_load_dwordx4 a[72:75], v11, s[4:7], s60 offen offset:0 sc1
    v_mfma_f32_16x16x32_bf16 v[104:107], a[216:219], v[44:47], v[104:107]
    v_mfma_f32_16x16x32_bf16 v[108:111], a[204:207], v[40:43], v[108:111]
    v_mfma_f32_16x16x32_bf16 v[108:111], a[220:223], v[44:47], v[108:111]
    v_mfma_f32_16x16x32_bf16 v[48:51], a[224:227], a[0:3], 0
    buffer_load_dwordx4 a[76:79], v11, s[4:7], s60 offen offset:1024 sc1
    v_mfma_f32_16x16x32_bf16 v[48:51], a[240:243], a[4:7], v[48:51]
    ds_read_b64_tr_b16 a[184:185], v23 offset:0
    v_mfma_f32_16x16x32_bf16 v[52:55], a[228:231], a[0:3], 0
    v_mul_f32 v80, v80, v88
    v_mul_f32 v81, v81, v89
    v_mfma_f32_16x16x32_bf16 v[52:55], a[244:247], a[4:7], v[52:55]
    v_mul_f32 v82, v82, v90
    v_mul_f32 v83, v83, v91
    v_mfma_f32_16x16x32_bf16 v[56:59], a[232:235], a[0:3], 0
    buffer_load_dwordx4 a[80:83], v11, s[4:7], s60 offen offset:2048 sc1
    v_mfma_f32_16x16x32_bf16 v[56:59], a[248:251], a[4:7], v[56:59]
    v_mul_f32 v84, v84, v92
    v_mul_f32 v85, v85, v93
    v_mfma_f32_16x16x32_bf16 v[60:63], a[236:239], a[0:3], 0
    v_mul_f32 v86, v86, v94
    v_mul_f32 v87, v87, v95
    v_mfma_f32_16x16x32_bf16 v[60:63], a[252:255], a[4:7], v[60:63]
    v_cvt_pk_bf16_f32 v88, v80, v81
    v_cvt_pk_bf16_f32 v89, v82, v83
    v_mfma_f32_16x16x32_bf16 v[48:51], v[112:115], a[8:11], v[48:51]
    buffer_load_dwordx4 a[84:87], v11, s[4:7], s60 offen offset:3072 sc1
    v_mfma_f32_16x16x32_bf16 v[48:51], v[128:131], a[12:15], v[48:51]
    v_cvt_pk_bf16_f32 v90, v84, v85
    v_cvt_pk_bf16_f32 v91, v86, v87
    v_mfma_f32_16x16x32_bf16 v[52:55], v[116:119], a[8:11], v[52:55]
    s_add_u32 s59, s61, 344064
    v_mul_f32 v96, v96, v104
    v_mfma_f32_16x16x32_bf16 v[52:55], v[132:135], a[12:15], v[52:55]
    v_mul_f32 v97, v97, v105
    v_mul_f32 v98, v98, v106
    v_mfma_f32_16x16x32_bf16 v[56:59], v[120:123], a[8:11], v[56:59]
    s_barrier
    v_mul_f32 v99, v99, v107
    v_mfma_f32_16x16x32_bf16 v[56:59], v[136:139], a[12:15], v[56:59]
    buffer_store_dwordx4 v[88:91], v11, s[4:7], s59 offen sc1
    v_mfma_f32_16x16x32_bf16 v[60:63], v[124:127], a[8:11], v[60:63]
    v_mul_f32 v100, v100, v108
    v_mul_f32 v101, v101, v109
    v_mfma_f32_16x16x32_bf16 v[60:63], v[140:143], a[12:15], v[60:63]
    v_mul_f32 v102, v102, v110
    s_waitcnt vmcnt(19)
    v_mfma_f32_16x16x32_bf16 v[48:51], v[144:147], a[16:19], v[48:51]
    v_mul_f32 v103, v103, v111
L_pg5:
    s_cbranch_execz L_warm
    s_waitcnt vmcnt(17)
    v_mfma_f32_16x16x32_bf16 v[48:51], v[160:163], a[20:23], v[48:51]
    v_cvt_pk_bf16_f32 v104, v96, v97
    v_cvt_pk_bf16_f32 v105, v98, v99
    v_mfma_f32_16x16x32_bf16 v[52:55], v[148:151], a[16:19], v[52:55]
    v_cvt_pk_bf16_f32 v106, v100, v101
    v_cvt_pk_bf16_f32 v107, v102, v103
    v_mfma_f32_16x16x32_bf16 v[52:55], v[164:167], a[20:23], v[52:55]
    s_add_u32 s59, s61, 401408
    ds_read_b64_tr_b16 a[186:187], v23 offset:2048
    v_mfma_f32_16x16x32_bf16 v[56:59], v[152:155], a[16:19], v[56:59]
    ds_read_b64_tr_b16 a[188:189], v23 offset:32
    ds_read_b64_tr_b16 a[190:191], v23 offset:2080
    v_mfma_f32_16x16x32_bf16 v[56:59], v[168:171], a[20:23], v[56:59]
    buffer_store_dwordx4 v[104:107], v11, s[4:7], s59 offen sc1
    v_mfma_f32_16x16x32_bf16 v[60:63], v[156:159], a[16:19], v[60:63]
    s_add_u32 s60, s65, 122880
    ds_read_b64_tr_b16 a[192:193], v23 offset:512
    v_mfma_f32_16x16x32_bf16 v[60:63], v[172:175], a[20:23], v[60:63]
    ds_read_b64_tr_b16 a[194:195], v23 offset:2560
    s_waitcnt vmcnt(17)
    v_mfma_f32_16x16x32_bf16 v[48:51], v[176:179], a[24:27], v[48:51]
    buffer_load_dwordx4 a[88:91], v11, s[4:7], s60 offen offset:0 sc1
    s_waitcnt vmcnt(17)
    v_mfma_f32_16x16x32_bf16 v[48:51], v[192:195], a[28:31], v[48:51]
    buffer_load_dwordx4 a[92:95], v11, s[4:7], s60 offen offset:1024 sc1
    v_mfma_f32_16x16x32_bf16 v[52:55], v[180:183], a[24:27], v[52:55]
    ds_read_b64_tr_b16 a[196:197], v23 offset:544
    ds_read_b64_tr_b16 a[198:199], v23 offset:2592
    v_mfma_f32_16x16x32_bf16 v[52:55], v[196:199], a[28:31], v[52:55]
    ds_read_b64_tr_b16 a[200:201], v23 offset:4096
    ds_read_b64_tr_b16 a[202:203], v23 offset:6144
    v_mfma_f32_16x16x32_bf16 v[56:59], v[184:187], a[24:27], v[56:59]
    buffer_load_dwordx4 a[96:99], v11, s[4:7], s60 offen offset:2048 sc1
    v_mfma_f32_16x16x32_bf16 v[56:59], v[200:203], a[28:31], v[56:59]
    ds_read_b64_tr_b16 a[204:205], v23 offset:4128
    ds_read_b64_tr_b16 a[206:207], v23 offset:6176
    v_mfma_f32_16x16x32_bf16 v[60:63], v[188:191], a[24:27], v[60:63]
    ds_read_b64_tr_b16 a[208:209], v23 offset:4608
    ds_read_b64_tr_b16 a[210:211], v23 offset:6656
    v_mfma_f32_16x16x32_bf16 v[60:63], v[204:207], a[28:31], v[60:63]
    ds_read_b64_tr_b16 a[212:213], v23 offset:4640
    s_waitcnt vmcnt(18)
    v_mfma_f32_16x16x32_bf16 v[48:51], v[208:211], a[32:35], v[48:51]
    ds_read_b64_tr_b16 a[214:215], v23 offset:6688
    s_waitcnt vmcnt(17)
    v_mfma_f32_16x16x32_bf16 v[48:51], v[224:227], a[36:39], v[48:51]
    buffer_load_dwordx4 a[100:103], v11, s[4:7], s60 offen offset:3072 sc1
    v_mfma_f32_16x16x32_bf16 v[52:55], v[212:215], a[32:35], v[52:55]
    s_add_u32 s60, s65, 126976
    v_mfma_f32_16x16x32_bf16 v[52:55], v[228:231], a[36:39], v[52:55]
    v_mfma_f32_16x16x32_bf16 v[56:59], v[216:219], a[32:35], v[56:59]
    buffer_load_dwordx4 a[104:107], v11, s[4:7], s60 offen offset:0 sc1
    v_mfma_f32_16x16x32_bf16 v[56:59], v[232:235], a[36:39], v[56:59]
    v_mfma_f32_16x16x32_bf16 v[60:63], v[220:223], a[32:35], v[60:63]
    v_mfma_f32_16x16x32_bf16 v[60:63], v[236:239], a[36:39], v[60:63]
    s_waitcnt vmcnt(18)
    v_mfma_f32_16x16x32_bf16 v[48:51], v[240:243], a[40:43], v[48:51]
    s_waitcnt vmcnt(17)
    s_waitcnt lgkmcnt(15)
    v_mfma_f32_16x16x32_bf16 v[48:51], a[168:171], a[44:47], v[48:51]
    buffer_load_dwordx4 a[108:111], v11, s[4:7], s60 offen offset:1024 sc1
    s_waitcnt vmcnt(17)
    s_waitcnt lgkmcnt(8)
    v_mfma_f32_16x16x32_bf16 v[48:51], a[184:187], a[48:51], v[48:51]
    s_waitcnt vmcnt(16)
    s_waitcnt lgkmcnt(0)
    v_mfma_f32_16x16x32_bf16 v[48:51], a[200:203], a[52:55], v[48:51]
    s_add_u32 s60, s65, 229376
    v_mfma_f32_16x16x32_bf16 v[52:55], v[244:247], a[40:43], v[52:55]
    buffer_load_dwordx4 a[112:115], v11, s[4:7], s60 offen offset:0 sc1
    v_mfma_f32_16x16x32_bf16 v[52:55], a[172:175], a[44:47], v[52:55]
    v_mfma_f32_16x16x32_bf16 v[52:55], a[188:191], a[48:51], v[52:55]
    v_mfma_f32_16x16x32_bf16 v[52:55], a[204:207], a[52:55], v[52:55]
    v_mfma_f32_16x16x32_bf16 v[56:59], v[248:251], a[40:43], v[56:59]
    buffer_load_dwordx4 a[116:119], v11, s[4:7], s60 offen offset:1024 sc1
    v_mfma_f32_16x16x32_bf16 v[56:59], a[176:179], a[44:47], v[56:59]
    v_mfma_f32_16x16x32_bf16 v[56:59], a[192:195], a[48:51], v[56:59]
    ds_write_b128 v2, v[48:51] offset:0
    v_mfma_f32_16x16x32_bf16 v[56:59], a[208:211], a[52:55], v[56:59]
    v_mfma_f32_16x16x32_bf16 v[60:63], v[252:255], a[40:43], v[60:63]
    buffer_load_dwordx4 a[120:123], v11, s[4:7], s60 offen offset:2048 sc1
    v_mfma_f32_16x16x32_bf16 v[60:63], a[180:183], a[44:47], v[60:63]
    v_mfma_f32_16x16x32_bf16 v[60:63], a[196:199], a[48:51], v[60:63]
    ds_write_b128 v2, v[52:55] offset:64
    v_mfma_f32_16x16x32_bf16 v[60:63], a[212:215], a[52:55], v[60:63]
    s_waitcnt vmcnt(18)
    v_mfma_f32_16x16x32_bf16 v[64:67], a[224:227], a[56:59], 0
    s_waitcnt vmcnt(17)
    v_mfma_f32_16x16x32_bf16 v[64:67], a[240:243], a[60:63], v[64:67]
    buffer_load_dwordx4 a[124:127], v11, s[4:7], s60 offen offset:3072 sc1
    v_mfma_f32_16x16x32_bf16 v[68:71], a[228:231], a[56:59], 0
    s_add_u32 s60, s65, 233472
    v_mfma_f32_16x16x32_bf16 v[68:71], a[244:247], a[60:63], v[68:71]
    ds_write_b128 v2, v[56:59] offset:128
    v_mfma_f32_16x16x32_bf16 v[72:75], a[232:235], a[56:59], 0
    buffer_load_dwordx4 a[128:131], v11, s[4:7], s60 offen offset:0 sc1
    v_mfma_f32_16x16x32_bf16 v[72:75], a[248:251], a[60:63], v[72:75]
    v_mfma_f32_16x16x32_bf16 v[76:79], a[236:239], a[56:59], 0
    ds_write_b128 v2, v[60:63] offset:192
    v_mfma_f32_16x16x32_bf16 v[76:79], a[252:255], a[60:63], v[76:79]
    s_waitcnt vmcnt(18)
    v_mfma_f32_16x16x32_bf16 v[64:67], v[112:115], a[64:67], v[64:67]
    s_waitcnt vmcnt(17)
    v_mfma_f32_16x16x32_bf16 v[64:67], v[128:131], a[68:71], v[64:67]
    buffer_load_dwordx4 a[132:135], v11, s[4:7], s60 offen offset:1024 sc1
    v_mfma_f32_16x16x32_bf16 v[68:71], v[116:119], a[64:67], v[68:71]
    v_mfma_f32_16x16x32_bf16 v[68:71], v[132:135], a[68:71], v[68:71]
    v_mfma_f32_16x16x32_bf16 v[72:75], v[120:123], a[64:67], v[72:75]
    buffer_load_dwordx4 a[136:139], v11, s[4:7], s60 offen offset:2048 sc1
    v_mfma_f32_16x16x32_bf16 v[72:75], v[136:139], a[68:71], v[72:75]
    v_mfma_f32_16x16x32_bf16 v[76:79], v[124:127], a[64:67], v[76:79]
    v_mfma_f32_16x16x32_bf16 v[76:79], v[140:143], a[68:71], v[76:79]
    s_waitcnt vmcnt(18)
    v_mfma_f32_16x16x32_bf16 v[64:67], v[144:147], a[72:75], v[64:67]
    s_waitcnt vmcnt(17)
    v_mfma_f32_16x16x32_bf16 v[64:67], v[160:163], a[76:79], v[64:67]
    buffer_load_dwordx4 v[12:15], v22, s[4:7], s49 offen sc1
    v_mfma_f32_16x16x32_bf16 v[68:71], v[148:151], a[72:75], v[68:71]
    v_mfma_f32_16x16x32_bf16 v[68:71], v[164:167], a[76:79], v[68:71]
    v_mfma_f32_16x16x32_bf16 v[72:75], v[152:155], a[72:75], v[72:75]
    buffer_load_dwordx4 a[140:143], v11, s[4:7], s60 offen offset:3072 sc1
    v_mfma_f32_16x16x32_bf16 v[72:75], v[168:171], a[76:79], v[72:75]
    s_add_u32 s60, s65, 237568
    v_mfma_f32_16x16x32_bf16 v[76:79], v[156:159], a[72:75], v[76:79]
    v_mfma_f32_16x16x32_bf16 v[76:79], v[172:175], a[76:79], v[76:79]
    s_waitcnt vmcnt(18)
    v_mfma_f32_16x16x32_bf16 v[64:67], v[176:179], a[80:83], v[64:67]
    s_waitcnt vmcnt(17)
    v_mfma_f32_16x16x32_bf16 v[64:67], v[192:195], a[84:87], v[64:67]
    buffer_load_dwordx4 a[144:147], v11, s[4:7], s60 offen offset:0 sc1
    v_mfma_f32_16x16x32_bf16 v[68:71], v[180:183], a[80:83], v[68:71]
    v_mfma_f32_16x16x32_bf16 v[68:71], v[196:199], a[84:87], v[68:71]
    v_mfma_f32_16x16x32_bf16 v[72:75], v[184:187], a[80:83], v[72:75]
    buffer_load_dwordx4 a[148:151], v11, s[4:7], s60 offen offset:1024 sc1
    v_mfma_f32_16x16x32_bf16 v[72:75], v[200:203], a[84:87], v[72:75]
    v_mfma_f32_16x16x32_bf16 v[76:79], v[188:191], a[80:83], v[76:79]
    v_mfma_f32_16x16x32_bf16 v[76:79], v[204:207], a[84:87], v[76:79]
    s_waitcnt vmcnt(16)
    v_mfma_f32_16x16x32_bf16 v[64:67], v[208:211], a[88:91], v[64:67]
    s_waitcnt vmcnt(15)
    v_mfma_f32_16x16x32_bf16 v[64:67], v[224:227], a[92:95], v[64:67]
    buffer_load_dwordx4 a[152:155], v11, s[4:7], s60 offen offset:2048 sc1
    v_mfma_f32_16x16x32_bf16 v[68:71], v[212:215], a[88:91], v[68:71]
    v_mfma_f32_16x16x32_bf16 v[68:71], v[228:231], a[92:95], v[68:71]
    v_mfma_f32_16x16x32_bf16 v[72:75], v[216:219], a[88:91], v[72:75]
    buffer_load_dwordx4 a[156:159], v11, s[4:7], s60 offen offset:3072 sc1
    v_mfma_f32_16x16x32_bf16 v[72:75], v[232:235], a[92:95], v[72:75]
    s_add_u32 s60, s65, 241664
    v_mfma_f32_16x16x32_bf16 v[76:79], v[220:223], a[88:91], v[76:79]
    v_mfma_f32_16x16x32_bf16 v[76:79], v[236:239], a[92:95], v[76:79]
    s_waitcnt vmcnt(16)
    v_mfma_f32_16x16x32_bf16 v[64:67], v[240:243], a[96:99], v[64:67]
    s_waitcnt vmcnt(15)
    v_mfma_f32_16x16x32_bf16 v[64:67], a[168:171], a[100:103], v[64:67]
    buffer_load_dwordx4 a[160:163], v11, s[4:7], s60 offen offset:0 sc1
    s_waitcnt vmcnt(15)
    v_mfma_f32_16x16x32_bf16 v[64:67], a[184:187], a[104:107], v[64:67]
    s_waitcnt vmcnt(14)
    v_mfma_f32_16x16x32_bf16 v[64:67], a[200:203], a[108:111], v[64:67]
    v_mfma_f32_16x16x32_bf16 v[68:71], v[244:247], a[96:99], v[68:71]
    buffer_load_dwordx4 a[164:167], v11, s[4:7], s60 offen offset:1024 sc1
    v_mfma_f32_16x16x32_bf16 v[68:71], a[172:175], a[100:103], v[68:71]
    s_add_u32 s60, s65, 344064
    v_mfma_f32_16x16x32_bf16 v[68:71], a[188:191], a[104:107], v[68:71]
    v_mfma_f32_16x16x32_bf16 v[68:71], a[204:207], a[108:111], v[68:71]
    v_mfma_f32_16x16x32_bf16 v[72:75], v[248:251], a[96:99], v[72:75]
    buffer_load_dwordx4 a[0:3], v11, s[4:7], s60 offen offset:0 sc1
    v_mfma_f32_16x16x32_bf16 v[72:75], a[176:179], a[100:103], v[72:75]
    s_waitcnt vmcnt(12)
    v_accvgpr_read_b32 v16, a115
    v_mfma_f32_16x16x32_bf16 v[72:75], a[192:195], a[104:107], v[72:75]
    ds_write_b128 v2, v[64:67] offset:17408
    v_mfma_f32_16x16x32_bf16 v[72:75], a[208:211], a[108:111], v[72:75]
    v_accvgpr_read_b32 v17, a119
    v_accvgpr_read_b32 v18, a123
    v_mfma_f32_16x16x32_bf16 v[76:79], v[252:255], a[96:99], v[76:79]
    buffer_load_dwordx4 a[4:7], v11, s[4:7], s60 offen offset:1024 sc1
    v_mfma_f32_16x16x32_bf16 v[76:79], a[180:183], a[100:103], v[76:79]
    v_accvgpr_read_b32 v19, a127
    v_max3_u32 v10, v16, v17, v18
    v_mfma_f32_16x16x32_bf16 v[76:79], a[196:199], a[104:107], v[76:79]
    ds_write_b128 v2, v[68:71] offset:17472
    v_mfma_f32_16x16x32_bf16 v[76:79], a[212:215], a[108:111], v[76:79]
    v_max_u32 v10, v10, v19
    v_cmp_eq_u32 vcc, -1, v10
    s_cbranch_vccnz L_q2_0_retry
L_q2_0_ok:
    v_mfma_f32_16x16x32_bf16 v[80:83], a[224:227], a[112:115], 0
    buffer_load_dwordx4 a[8:11], v11, s[4:7], s60 offen offset:2048 sc1
    v_mfma_f32_16x16x32_bf16 v[80:83], a[240:243], a[116:119], v[80:83]
    v_mfma_f32_16x16x32_bf16 v[84:87], a[228:231], a[112:115], 0
    ds_write_b128 v2, v[72:75] offset:17536
    v_mfma_f32_16x16x32_bf16 v[84:87], a[244:247], a[116:119], v[84:87]
    v_mfma_f32_16x16x32_bf16 v[88:91], a[232:235], a[112:115], 0
    buffer_load_dwordx4 a[12:15], v11, s[4:7], s60 offen offset:3072 sc1
    v_mfma_f32_16x16x32_bf16 v[88:91], a[248:251], a[116:119], v[88:91]
    s_add_u32 s60, s65, 348160
    v_mfma_f32_16x16x32_bf16 v[92:95], a[236:239], a[112:115], 0
    ds_write_b128 v2, v[76:79] offset:17600
    v_mfma_f32_16x16x32_bf16 v[92:95], a[252:255], a[116:119], v[92:95]
    v_mfma_f32_16x16x32_bf16 v[80:83], v[112:115], a[120:123], v[80:83]
    buffer_load_dwordx4 a[16:19], v11, s[4:7], s60 offen offset:0 sc1
    v_mfma_f32_16x16x32_bf16 v[80:83], v[128:131], a[124:127], v[80:83]
    s_waitcnt vmcnt(11)
    v_accvgpr_read_b32 v16, a131
    v_mfma_f32_16x16x32_bf16 v[84:87], v[116:119], a[120:123], v[84:87]
    v_accvgpr_read_b32 v17, a135
    v_accvgpr_read_b32 v18, a139
    v_mfma_f32_16x16x32_bf16 v[84:87], v[132:135], a[124:127], v[84:87]
    v_accvgpr_read_b32 v19, a143
    v_max3_u32 v10, v16, v17, v18
    v_mfma_f32_16x16x32_bf16 v[88:91], v[120:123], a[120:123], v[88:91]
    buffer_load_dwordx4 a[20:23], v11, s[4:7], s60 offen offset:1024 sc1
    v_mfma_f32_16x16x32_bf16 v[88:91], v[136:139], a[124:127], v[88:91]
    s_waitcnt lgkmcnt(0)
    s_barrier
    v_mfma_f32_16x16x32_bf16 v[92:95], v[124:127], a[120:123], v[92:95]
    v_max_u32 v10, v10, v19
    v_cmp_eq_u32 vcc, -1, v10
    s_cbranch_vccnz L_q2_4_retry
L_q2_4_ok:
    v_mfma_f32_16x16x32_bf16 v[92:95], v[140:143], a[124:127], v[92:95]
    ds_read_b128 v[48:51], v5 offset:0
    ds_read_b128 v[52:55], v5 offset:16
    v_mfma_f32_16x16x32_bf16 v[80:83], v[144:147], a[128:131], v[80:83]
    buffer_load_dwordx4 a[24:27], v11, s[4:7], s60 offen offset:2048 sc1
    v_mfma_f32_16x16x32_bf16 v[80:83], v[160:163], a[132:135], v[80:83]
    ds_read_b128 v[56:59], v5 offset:4352
    ds_read_b128 v[60:63], v5 offset:4368
    v_mfma_f32_16x16x32_bf16 v[84:87], v[148:151], a[128:131], v[84:87]
    ds_read_b128 v[64:67], v5 offset:8704
    ds_read_b128 v[68:71], v5 offset:8720
    v_mfma_f32_16x16x32_bf16 v[84:87], v[164:167], a[132:135], v[84:87]
    ds_read_b128 v[72:75], v5 offset:13056
    ds_read_b128 v[76:79], v5 offset:13072
    v_mfma_f32_16x16x32_bf16 v[88:91], v[152:155], a[128:131], v[88:91]
    buffer_load_dwordx4 a[28:31], v11, s[4:7], s60 offen offset:3072 sc1
    v_mfma_f32_16x16x32_bf16 v[88:91], v[168:171], a[132:135], v[88:91]
    s_add_u32 s60, s65, 352256
    v_mfma_f32_16x16x32_bf16 v[92:95], v[156:159], a[128:131], v[92:95]
    v_mfma_f32_16x16x32_bf16 v[92:95], v[172:175], a[132:135], v[92:95]
    s_waitcnt lgkmcnt(4)
    v_add_f32 v48, v48, v56
    v_mfma_f32_16x16x32_bf16 v[80:83], v[176:179], a[136:139], v[80:83]
    buffer_load_dwordx4 a[32:35], v11, s[4:7], s60 offen offset:0 sc1
    v_mfma_f32_16x16x32_bf16 v[80:83], v[192:195], a[140:143], v[80:83]
    s_waitcnt vmcnt(13)
    v_accvgpr_read_b32 v16, a147
    v_mfma_f32_16x16x32_bf16 v[84:87], v[180:183], a[136:139], v[84:87]
    v_accvgpr_read_b32 v17, a151
    v_max_u32 v10, v16, v17
    v_mfma_f32_16x16x32_bf16 v[84:87], v[196:199], a[140:143], v[84:87]
    v_cmp_eq_u32 vcc, -1, v10
    s_cbranch_vccnz L_q2_8_retry
L_q2_8_ok:
    v_mfma_f32_16x16x32_bf16 v[88:91], v[184:187], a[136:139], v[88:91]
    buffer_load_dwordx4 a[36:39], v11, s[4:7], s60 offen offset:1024 sc1
    v_mfma_f32_16x16x32_bf16 v[88:91], v[200:203], a[140:143], v[88:91]
    v_add_f32 v49, v49, v57
    v_add_f32 v50, v50, v58
    v_mfma_f32_16x16x32_bf16 v[92:95], v[188:191], a[136:139], v[92:95]
    v_add_f32 v51, v51, v59
    v_add_f32 v52, v52, v60
    v_mfma_f32_16x16x32_bf16 v[92:95], v[204:207], a[140:143], v[92:95]
    v_add_f32 v53, v53, v61
    v_add_f32 v54, v54, v62
    v_mfma_f32_16x16x32_bf16 v[80:83], v[208:211], a[144:147], v[80:83]
    buffer_load_dwordx4 a[40:43], v11, s[4:7], s60 offen offset:2048 sc1
    v_mfma_f32_16x16x32_bf16 v[80:83], v[224:227], a[148:151], v[80:83]
    s_waitcnt vmcnt(11)
    v_accvgpr_read_b32 v16, a155
    v_mfma_f32_16x16x32_bf16 v[84:87], v[212:215], a[144:147], v[84:87]
    v_accvgpr_read_b32 v17, a159
    v_accvgpr_read_b32 v18, a163
    v_mfma_f32_16x16x32_bf16 v[84:87], v[228:231], a[148:151], v[84:87]
    v_accvgpr_read_b32 v19, a167
    v_max3_u32 v10, v16, v17, v18
    v_mfma_f32_16x16x32_bf16 v[88:91], v[216:219], a[144:147], v[88:91]
    buffer_load_dwordx4 a[44:47], v11, s[4:7], s60 offen offset:3072 sc1
    v_mfma_f32_16x16x32_bf16 v[88:91], v[232:235], a[148:151], v[88:91]
    s_add_u32 s60, s65, 356352
    v_max_u32 v10, v10, v19
    v_mfma_f32_16x16x32_bf16 v[92:95], v[220:223], a[144:147], v[92:95]
    v_cmp_eq_u32 vcc, -1, v10
    s_cbranch_vccnz L_q2_10_retry
L_q2_10_ok:
    v_mfma_f32_16x16x32_bf16 v[92:95], v[236:239], a[148:151], v[92:95]
    v_add_f32 v55, v55, v63
    s_waitcnt lgkmcnt(2)
    v_mfma_f32_16x16x32_bf16 v[80:83], v[240:243], a[152:155], v[80:83]
    buffer_load_dwordx4 a[48:51], v11, s[4:7], s60 offen offset:0 sc1
    v_mfma_f32_16x16x32_bf16 v[80:83], a[168:171], a[156:159], v[80:83]
    v_add_f32 v48, v48, v64
    v_add_f32 v49, v49, v65
    v_mfma_f32_16x16x32_bf16 v[80:83], a[184:187], a[160:163], v[80:83]
    v_add_f32 v50, v50, v66
    v_add_f32 v51, v51, v67
    v_mfma_f32_16x16x32_bf16 v[80:83], a[200:203], a[164:167], v[80:83]
    v_add_f32 v52, v52, v68
    v_add_f32 v53, v53, v69
    v_mfma_f32_16x16x32_bf16 v[84:87], v[244:247], a[152:155], v[84:87]
    buffer_load_dwordx4 a[52:55], v11, s[4:7], s60 offen offset:1024 sc1
    v_mfma_f32_16x16x32_bf16 v[84:87], a[172:175], a[156:159], v[84:87]
    v_add_f32 v54, v54, v70
    v_add_f32 v55, v55, v71
    v_mfma_f32_16x16x32_bf16 v[84:87], a[188:191], a[160:163], v[84:87]
    s_waitcnt lgkmcnt(0)
    v_add_f32 v48, v48, v72
    v_mfma_f32_16x16x32_bf16 v[84:87], a[204:207], a[164:167], v[84:87]
    v_add_f32 v49, v49, v73
    v_add_f32 v50, v50, v74
    v_mfma_f32_16x16x32_bf16 v[88:91], v[248:251], a[152:155], v[88:91]
    buffer_load_dwordx4 v[28:31], v4, s[4:7], s47 offen sc1
    v_mfma_f32_16x16x32_bf16 v[88:91], a[176:179], a[156:159], v[88:91]
    s_waitcnt vmcnt(11)
    v_accvgpr_read_b32 v16, a3
    v_mfma_f32_16x16x32_bf16 v[88:91], a[192:195], a[160:163], v[88:91]
    ds_write_b128 v2, v[80:83] offset:34816
    v_mfma_f32_16x16x32_bf16 v[88:91], a[208:211], a[164:167], v[88:91]
    v_accvgpr_read_b32 v17, a7
    v_accvgpr_read_b32 v18, a11
    v_mfma_f32_16x16x32_bf16 v[92:95], v[252:255], a[152:155], v[92:95]
    v_accvgpr_read_b32 v19, a15
    v_max3_u32 v10, v16, v17, v18
    v_mfma_f32_16x16x32_bf16 v[92:95], a[180:183], a[156:159], v[92:95]
    ds_write_b128 v2, v[84:87] offset:34880
    v_mfma_f32_16x16x32_bf16 v[92:95], a[196:199], a[160:163], v[92:95]
    v_max_u32 v10, v10, v19
    v_cmp_eq_u32 vcc, -1, v10
    s_cbranch_vccnz L_q3_0_retry
L_q3_0_ok:
    v_mfma_f32_16x16x32_bf16 v[92:95], a[212:215], a[164:167], v[92:95]
    v_add_f32 v51, v51, v75
    v_add_f32 v52, v52, v76
    v_mfma_f32_16x16x32_bf16 v[96:99], a[224:227], a[0:3], 0
    v_add_f32 v53, v53, v77
    v_add_f32 v54, v54, v78
    v_mfma_f32_16x16x32_bf16 v[96:99], a[240:243], a[4:7], v[96:99]
    ds_write_b128 v2, v[88:91] offset:34944
    v_mfma_f32_16x16x32_bf16 v[100:103], a[228:231], a[0:3], 0
    v_add_f32 v55, v55, v79
    s_barrier
    v_mfma_f32_16x16x32_bf16 v[100:103], a[244:247], a[4:7], v[100:103]
    v_lshlrev_b32 v56, 16, v12
    v_and_b32 v57, 0xffff0000, v12
    v_mfma_f32_16x16x32_bf16 v[104:107], a[232:235], a[0:3], 0
    v_cmp_u_f32 vcc, v92, v92
    s_cbranch_vccnz L_g2_nan
L_g2_ok:
    v_mfma_f32_16x16x32_bf16 v[104:107], a[248:251], a[4:7], v[104:107]
    v_lshlrev_b32 v64, 16, v24
    v_and_b32 v65, 0xffff0000, v24
    v_mfma_f32_16x16x32_bf16 v[108:111], a[236:239], a[0:3], 0
    ds_write_b128 v2, v[92:95] offset:35008
    v_mfma_f32_16x16x32_bf16 v[108:111], a[252:255], a[4:7], v[108:111]
    v_lshlrev_b32 v58, 16, v13
    v_and_b32 v59, 0xffff0000, v13
    v_mfma_f32_16x16x32_bf16 v[96:99], v[112:115], a[8:11], v[96:99]
    v_lshlrev_b32 v66, 16, v25
    v_and_b32 v67, 0xffff0000, v25
    v_mfma_f32_16x16x32_bf16 v[96:99], v[128:131], a[12:15], v[96:99]
    s_waitcnt vmcnt(7)
    v_accvgpr_read_b32 v16, a19
    v_mfma_f32_16x16x32_bf16 v[100:103], v[116:119], a[8:11], v[100:103]
    v_accvgpr_read_b32 v17, a23
    v_accvgpr_read_b32 v18, a27
    v_mfma_f32_16x16x32_bf16 v[100:103], v[132:135], a[12:15], v[100:103]
    v_accvgpr_read_b32 v19, a31
    v_max3_u32 v10, v16, v17, v18
    v_mfma_f32_16x16x32_bf16 v[104:107], v[120:123], a[8:11], v[104:107]
    v_max_u32 v10, v10, v19
    v_cmp_eq_u32 vcc, -1, v10
    s_cbranch_vccnz L_q3_4_retry
L_q3_4_ok:
    v_mfma_f32_16x16x32_bf16 v[104:107], v[136:139], a[12:15], v[104:107]
    v_lshlrev_b32 v60, 16, v14
    v_and_b32 v61, 0xffff0000, v14
    v_mfma_f32_16x16x32_bf16 v[108:111], v[124:127], a[8:11], v[108:111]
    v_lshlrev_b32 v68, 16, v26
    v_and_b32 v69, 0xffff0000, v26
    v_mfma_f32_16x16x32_bf16 v[108:111], v[140:143], a[12:15], v[108:111]
    v_lshlrev_b32 v62, 16, v15
    v_and_b32 v63, 0xffff0000, v15
    v_mfma_f32_16x16x32_bf16 v[96:99], v[144:147], a[16:19], v[96:99]
    v_lshlrev_b32 v70, 16, v27
    v_and_b32 v71, 0xffff0000, v27
    v_mfma_f32_16x16x32_bf16 v[96:99], v[160:163], a[20:23], v[96:99]
    v_fma_f32 v48, v48, v56, v64
    v_fma_f32 v49, v49, v57, v65
    v_mfma_f32_16x16x32_bf16 v[100:103], v[148:151], a[16:19], v[100:103]
    v_fma_f32 v50, v50, v58, v66
    v_fma_f32 v51, v51, v59, v67
    v_mfma_f32_16x16x32_bf16 v[100:103], v[164:167], a[20:23], v[100:103]
    v_fma_f32 v52, v52, v60, v68
    v_fma_f32 v53, v53, v61, v69
    v_mfma_f32_16x16x32_bf16 v[104:107], v[152:155], a[16:19], v[104:107]
    v_fma_f32 v54, v54, v62, v70
    v_fma_f32 v55, v55, v63, v71
    v_mfma_f32_16x16x32_bf16 v[104:107], v[168:171], a[20:23], v[104:107]
    v_cvt_pk_bf16_f32 v72, v48, v49
    v_cvt_pk_bf16_f32 v73, v50, v51
    v_mfma_f32_16x16x32_bf16 v[108:111], v[156:159], a[16:19], v[108:111]
    v_cvt_pk_bf16_f32 v74, v52, v53
    v_cvt_pk_bf16_f32 v75, v54, v55
    v_mfma_f32_16x16x32_bf16 v[108:111], v[172:175], a[20:23], v[108:111]
    v_mfma_f32_16x16x32_bf16 v[96:99], v[176:179], a[24:27], v[96:99]
    buffer_store_dwordx4 v[72:75], v4, s[40:43], s48 offen sc1
    v_mfma_f32_16x16x32_bf16 v[96:99], v[192:195], a[28:31], v[96:99]
    s_waitcnt vmcnt(6)
    v_accvgpr_read_b32 v16, a35
    v_mfma_f32_16x16x32_bf16 v[100:103], v[180:183], a[24:27], v[100:103]
    v_accvgpr_read_b32 v17, a39
    v_max_u32 v10, v16, v17
    v_mfma_f32_16x16x32_bf16 v[100:103], v[196:199], a[28:31], v[100:103]
    v_cmp_eq_u32 vcc, -1, v10
    s_cbranch_vccnz L_q3_8_retry
L_q3_8_ok:
    v_mfma_f32_16x16x32_bf16 v[104:107], v[184:187], a[24:27], v[104:107]
    s_add_u32 s48, s48, 57344
    s_waitcnt vmcnt(1)
    v_mfma_f32_16x16x32_bf16 v[104:107], v[200:203], a[28:31], v[104:107]
    v_lshlrev_b32 v64, 16, v28
    v_and_b32 v65, 0xffff0000, v28
    v_mfma_f32_16x16x32_bf16 v[108:111], v[188:191], a[24:27], v[108:111]
    v_lshlrev_b32 v66, 16, v29
    v_and_b32 v67, 0xffff0000, v29
    v_mfma_f32_16x16x32_bf16 v[108:111], v[204:207], a[28:31], v[108:111]
    v_lshlrev_b32 v68, 16, v30
    v_and_b32 v69, 0xffff0000, v30
    v_mfma_f32_16x16x32_bf16 v[96:99], v[208:211], a[32:35], v[96:99]
    v_lshlrev_b32 v70, 16, v31
    v_and_b32 v71, 0xffff0000, v31
    v_mfma_f32_16x16x32_bf16 v[96:99], v[224:227], a[36:39], v[96:99]
    v_accvgpr_read_b32 v16, a43
    v_accvgpr_read_b32 v17, a47
    v_mfma_f32_16x16x32_bf16 v[100:103], v[212:215], a[32:35], v[100:103]
    v_accvgpr_read_b32 v18, a51
    v_accvgpr_read_b32 v19, a55
    v_mfma_f32_16x16x32_bf16 v[100:103], v[228:231], a[36:39], v[100:103]
    v_max3_u32 v10, v16, v17, v18
    v_max_u32 v10, v10, v19
    v_mfma_f32_16x16x32_bf16 v[104:107], v[216:219], a[32:35], v[104:107]
    v_cmp_eq_u32 vcc, -1, v10
    s_cbranch_vccnz L_q3_10_retry
L_q3_10_ok:
    v_mfma_f32_16x16x32_bf16 v[104:107], v[232:235], a[36:39], v[104:107]
    v_add_u32 v5, s63, v5
    v_mfma_f32_16x16x32_bf16 v[108:111], v[220:223], a[32:35], v[108:111]
    v_mfma_f32_16x16x32_bf16 v[108:111], v[236:239], a[36:39], v[108:111]
    v_mfma_f32_16x16x32_bf16 v[96:99], v[240:243], a[40:43], v[96:99]
    v_mfma_f32_16x16x32_bf16 v[96:99], a[168:171], a[44:47], v[96:99]
    v_mfma_f32_16x16x32_bf16 v[96:99], a[184:187], a[48:51], v[96:99]
    v_mfma_f32_16x16x32_bf16 v[96:99], a[200:203], a[52:55], v[96:99]
    v_mfma_f32_16x16x32_bf16 v[100:103], v[244:247], a[40:43], v[100:103]
    v_mfma_f32_16x16x32_bf16 v[100:103], a[172:175], a[44:47], v[100:103]
    v_mfma_f32_16x16x32_bf16 v[100:103], a[188:191], a[48:51], v[100:103]
    v_mfma_f32_16x16x32_bf16 v[100:103], a[204:207], a[52:55], v[100:103]
    v_mfma_f32_16x16x32_bf16 v[104:107], v[248:251], a[40:43], v[104:107]
    v_mfma_f32_16x16x32_bf16 v[104:107], a[176:179], a[44:47], v[104:107]
    v_mfma_f32_16x16x32_bf16 v[104:107], a[192:195], a[48:51], v[104:107]
    s_nop 0
    ds_write_b128 v2, v[96:99] offset:0
    v_mfma_f32_16x16x32_bf16 v[104:107], a[208:211], a[52:55], v[104:107]
    v_mfma_f32_16x16x32_bf16 v[108:111], v[252:255], a[40:43], v[108:111]
    v_mfma_f32_16x16x32_bf16 v[108:111], a[180:183], a[44:47], v[108:111]
    ds_write_b128 v2, v[100:103] offset:64
    v_mfma_f32_16x16x32_bf16 v[108:111], a[196:199], a[48:51], v[108:111]
    v_mfma_f32_16x16x32_bf16 v[108:111], a[212:215], a[52:55], v[108:111]
    s_nop 2
    ds_write_b128 v2, v[104:107] offset:128
    s_nop 3
    v_cmp_u_f32 vcc, v108, v108
    s_cbranch_vccnz L_g3_nan
L_g3_ok:
    ds_write_b128 v2, v[108:111] offset:192
    s_waitcnt lgkmcnt(0)
    s_barrier
    ds_read_b128 v[80:83], v5 offset:0
    ds_read_b128 v[84:87], v5 offset:16
    ds_read_b128 v[88:91], v5 offset:4352
    ds_read_b128 v[92:95], v5 offset:4368
    ds_read_b128 v[96:99], v5 offset:8704
    ds_read_b128 v[100:103], v5 offset:8720
    ds_read_b128 v[104:107], v5 offset:13056
    ds_read_b128 v[108:111], v5 offset:13072
    s_waitcnt lgkmcnt(4)
    v_pk_add_f32 v[80:81], v[80:81], v[88:89]
    v_pk_add_f32 v[82:83], v[82:83], v[90:91]
    v_pk_add_f32 v[84:85], v[84:85], v[92:93]
    v_pk_add_f32 v[86:87], v[86:87], v[94:95]
    s_waitcnt lgkmcnt(2)
    v_pk_add_f32 v[80:81], v[80:81], v[96:97]
    v_pk_add_f32 v[82:83], v[82:83], v[98:99]
    v_pk_add_f32 v[84:85], v[84:85], v[100:101]
    v_pk_add_f32 v[86:87], v[86:87], v[102:103]
    s_waitcnt lgkmcnt(0)
    v_pk_add_f32 v[80:81], v[80:81], v[104:105]
    v_pk_add_f32 v[82:83], v[82:83], v[106:107]
    v_pk_add_f32 v[84:85], v[84:85], v[108:109]
    v_pk_add_f32 v[86:87], v[86:87], v[110:111]
    v_pk_fma_f32 v[80:81], v[80:81], v[56:57], v[64:65]
    v_pk_fma_f32 v[82:83], v[82:83], v[58:59], v[66:67]
    v_pk_fma_f32 v[84:85], v[84:85], v[60:61], v[68:69]
    v_pk_fma_f32 v[86:87], v[86:87], v[62:63], v[70:71]
    v_cvt_pk_bf16_f32 v104, v80, v81
    v_cvt_pk_bf16_f32 v105, v82, v83
    v_cvt_pk_bf16_f32 v106, v84, v85
    v_cvt_pk_bf16_f32 v107, v86, v87
    buffer_store_dwordx4 v[104:107], v4, s[40:43], s48 offen sc1
L_exit:
L_end:
    s_endpgm
L_fa_retry:
    s_mov_b32 s67, 0
L_fa_loop:
    buffer_load_dwordx2 v[126:127], v15, s[4:7], 0 offen sc1
    s_waitcnt vmcnt(0) lgkmcnt(0)
    v_cmp_ne_u64 vcc, s[50:51], v[126:127]
    s_cbranch_vccz L_fa_ok
    s_add_u32 s67, s67, 1
    s_cmp_lt_u32 s67, 65536
    s_cbranch_scc1 L_fa_loop
    s_branch L_fa_ok
L_u_retry:
    s_mov_b32 s67, 0
L_u_loop:
    buffer_load_dwordx4 v[104:107], v30, s[4:7], s62 offen sc1
    buffer_load_dwordx4 v[108:111], v30, s[4:7], s63 offen sc1
    s_waitcnt vmcnt(0) lgkmcnt(0)
    v_or3_b32 v36, v104, v105, v106
    v_or3_b32 v36, v36, v107, v108
    v_or3_b32 v36, v36, v109, v110
    v_bitop3_b32 v36, v36, v111, 1 bitop3:0xa8
    v_cmp_ne_u32 vcc, 0, v36
    s_cbranch_vccz L_u_ok
    s_add_u32 s67, s67, 1
    s_cmp_lt_u32 s67, 65536
    s_cbranch_scc1 L_u_loop
    s_branch L_u_ok
.p2align 12
L_helper:
    v_lshlrev_b32 v11, 4, v1
    s_mov_b64 s[24:25], s[56:57]
    s_mov_b64 s[28:29], s[70:71]
    s_mov_b64 s[32:33], s[72:73]
    s_mov_b64 s[36:37], s[74:75]
    s_mov_b32 s26, 1835008
    s_mov_b32 s27, s7
    s_mov_b32 s30, 1605632
    s_mov_b32 s31, s7
    s_mov_b32 s34, s30
    s_mov_b32 s35, s7
    s_mov_b32 s38, s30
    s_mov_b32 s39, s7
    s_mov_b32 s42, s26
    s_mov_b32 s43, s7
    s_and_b32 s57, s53, 7
    s_lshl_b32 s57, s57, 5
    s_and_b32 s58, s53, 24
    s_add_u32 s57, s57, s58
    s_lshl_b32 s58, s52, 8
    s_add_u32 s57, s57, s58
    s_lshr_b32 s58, s3, 1
    s_add_u32 s57, s57, s58
    s_and_b32 s58, s3, 1
    s_lshl_b32 s58, s58, 2
    s_add_u32 s57, s57, s58
    v_lshrrev_b32 v2, 5, v1
    v_lshl_add_u32 v2, v2, 1, s57
    v_and_b32 v24, 31, v1
    v_bfe_u32 v25, v2, 1, 3
    v_mul_u32_u24 v2, 896, v2
    v_xor_b32 v25, v25, v24
    v_lshl_add_u32 v26, v24, 4, v2
    v_lshl_add_u32 v28, v25, 4, v2
    v_cmp_gt_u32 vcc, 24, v24
    v_mov_b32 v25, 0x80000000
    v_add_u32 v27, 512, v26
    v_add_u32 v29, 512, v28
    v_cndmask_b32 v27, v25, v27, vcc
    v_cndmask_b32 v29, v25, v29, vcc
    s_mov_b32 s6, 18874368
    v_mov_b32 v120, -1
    v_mov_b32 v121, -1
    v_mov_b32 v122, -1
    v_mov_b32 v123, -1
    v_mov_b32 v20, 0x80000000
    v_mov_b32 v21, 0
    v_mov_b32 v22, 0
    s_mov_b32 s60, 0
    s_mov_b32 s1, 0
    s_mov_b32 s14, 0
    s_mov_b32 s15, 0
    s_and_b32 s57, s3, 1
    s_cmp_eq_u32 s57, 0
    s_cselect_b32 s8, s28, s32
    s_cselect_b32 s9, s29, s33
    s_mov_b32 s10, s30
    s_mov_b32 s11, s7
    v_lshrrev_b32 v16, 4, v1
    v_mul_u32_u24 v16, 112, v16
    v_and_b32 v17, 15, v1
    v_min_u32 v17, 13, v17
    v_add_lshl_u32 v16, v16, v17, 7
    s_lshr_b32 s57, s52, 1
    s_mul_i32 s57, s57, 3584
    s_and_b32 s58, s52, 1
    s_mul_i32 s58, s58, 1792
    s_add_u32 s45, s57, s58
    s_waitcnt vmcnt(10)
    v_lshlrev_b32 v10, 16, v5
    v_and_b32 v9, 0xffff0000, v5
    v_mul_f32 v12, 0xbfb8aa3b, v10
    v_exp_f32 v12, v12
    s_nop 0
    v_add_f32 v12, 1.0, v12
    v_rcp_f32 v12, v12
    s_nop 0
    v_mul_f32 v10, v10, v12
    v_mul_f32 v12, 0xbfb8aa3b, v9
    v_exp_f32 v12, v12
    s_nop 0
    v_add_f32 v12, 1.0, v12
    v_rcp_f32 v12, v12
    s_nop 0
    v_mul_f32 v9, v9, v12
    v_cvt_pk_bf16_f32 v5, v10, v9
    v_lshlrev_b32 v10, 16, v5
    v_and_b32 v9, 0xffff0000, v5
    v_and_b32 v12, 7, v0
    v_lshlrev_b32 v12, 8, v12
    v_lshrrev_b32 v13, 3, v0
    v_lshl_add_u32 v12, v13, 2, v12
    ds_write2_b32 v12, v10, v9 offset0:0 offset1:32
    v_lshlrev_b32 v12, 7, v14
    buffer_load_dwordx4 v[168:171], v8, s[20:23], s44 offen
    s_add_u32 s44, s44, s46
    buffer_load_dwordx4 v[172:175], v8, s[20:23], s44 offen
    s_add_u32 s44, s44, s46
    buffer_load_dwordx4 v[176:179], v8, s[20:23], s44 offen
    s_add_u32 s44, s44, s46
    buffer_load_dwordx4 v[180:183], v8, s[20:23], s44 offen
    s_add_u32 s44, s44, s46
    s_waitcnt lgkmcnt(0)
    s_barrier
    ds_read_b128 v[32:35], v12 offset:0
    ds_read_b128 v[36:39], v12 offset:16
    ds_read_b128 v[40:43], v12 offset:32
    ds_read_b128 v[44:47], v12 offset:48
    ds_read_b128 v[48:51], v12 offset:64
    ds_read_b128 v[52:55], v12 offset:80
    ds_read_b128 v[56:59], v12 offset:96
    s_waitcnt lgkmcnt(0)
    buffer_load_dwordx4 v[184:187], v8, s[20:23], s44 offen
    s_add_u32 s44, s44, s46
    s_waitcnt vmcnt(14)
    v_lshlrev_b32 v64, 16, v128
    v_and_b32 v65, 0xffff0000, v128
    v_lshlrev_b32 v66, 16, v129
    v_and_b32 v67, 0xffff0000, v129
    v_lshlrev_b32 v68, 16, v130
    v_and_b32 v69, 0xffff0000, v130
    v_lshlrev_b32 v70, 16, v131
    v_and_b32 v71, 0xffff0000, v131
    v_pk_mul_f32 v[72:73], v[64:65], v[32:33] op_sel:[0,0] op_sel_hi:[1,0]
    v_pk_mul_f32 v[74:75], v[66:67], v[32:33] op_sel:[0,0] op_sel_hi:[1,0]
    v_pk_mul_f32 v[76:77], v[68:69], v[32:33] op_sel:[0,0] op_sel_hi:[1,0]
    v_pk_mul_f32 v[78:79], v[70:71], v[32:33] op_sel:[0,0] op_sel_hi:[1,0]
    buffer_load_dwordx4 v[188:191], v8, s[20:23], s44 offen
    s_add_u32 s44, s44, s46
    s_waitcnt vmcnt(14)
    v_lshlrev_b32 v64, 16, v132
    v_and_b32 v65, 0xffff0000, v132
    v_lshlrev_b32 v66, 16, v133
    v_and_b32 v67, 0xffff0000, v133
    v_lshlrev_b32 v68, 16, v134
    v_and_b32 v69, 0xffff0000, v134
    v_lshlrev_b32 v70, 16, v135
    v_and_b32 v71, 0xffff0000, v135
    v_pk_fma_f32 v[72:73], v[64:65], v[32:33], v[72:73] op_sel:[0,1,0] op_sel_hi:[1,1,1]
    v_pk_fma_f32 v[74:75], v[66:67], v[32:33], v[74:75] op_sel:[0,1,0] op_sel_hi:[1,1,1]
    v_pk_fma_f32 v[76:77], v[68:69], v[32:33], v[76:77] op_sel:[0,1,0] op_sel_hi:[1,1,1]
    v_pk_fma_f32 v[78:79], v[70:71], v[32:33], v[78:79] op_sel:[0,1,0] op_sel_hi:[1,1,1]
    buffer_load_dwordx4 v[192:195], v8, s[20:23], s44 offen
    s_add_u32 s44, s44, s46
    s_waitcnt vmcnt(14)
    v_lshlrev_b32 v64, 16, v136
    v_and_b32 v65, 0xffff0000, v136
    v_lshlrev_b32 v66, 16, v137
    v_and_b32 v67, 0xffff0000, v137
    v_lshlrev_b32 v68, 16, v138
    v_and_b32 v69, 0xffff0000, v138
    v_lshlrev_b32 v70, 16, v139
    v_and_b32 v71, 0xffff0000, v139
    v_pk_fma_f32 v[72:73], v[64:65], v[34:35], v[72:73] op_sel:[0,0,0] op_sel_hi:[1,0,1]
    v_pk_fma_f32 v[74:75], v[66:67], v[34:35], v[74:75] op_sel:[0,0,0] op_sel_hi:[1,0,1]
    v_pk_fma_f32 v[76:77], v[68:69], v[34:35], v[76:77] op_sel:[0,0,0] op_sel_hi:[1,0,1]
    v_pk_fma_f32 v[78:79], v[70:71], v[34:35], v[78:79] op_sel:[0,0,0] op_sel_hi:[1,0,1]
    buffer_load_dwordx4 v[196:199], v8, s[20:23], s44 offen
    s_add_u32 s44, s44, s46
    s_waitcnt vmcnt(14)
    v_lshlrev_b32 v64, 16, v140
    v_and_b32 v65, 0xffff0000, v140
    v_lshlrev_b32 v66, 16, v141
    v_and_b32 v67, 0xffff0000, v141
    v_lshlrev_b32 v68, 16, v142
    v_and_b32 v69, 0xffff0000, v142
    v_lshlrev_b32 v70, 16, v143
    v_and_b32 v71, 0xffff0000, v143
    v_pk_fma_f32 v[72:73], v[64:65], v[34:35], v[72:73] op_sel:[0,1,0] op_sel_hi:[1,1,1]
    v_pk_fma_f32 v[74:75], v[66:67], v[34:35], v[74:75] op_sel:[0,1,0] op_sel_hi:[1,1,1]
    v_pk_fma_f32 v[76:77], v[68:69], v[34:35], v[76:77] op_sel:[0,1,0] op_sel_hi:[1,1,1]
    v_pk_fma_f32 v[78:79], v[70:71], v[34:35], v[78:79] op_sel:[0,1,0] op_sel_hi:[1,1,1]
    buffer_load_dwordx4 v[200:203], v8, s[20:23], s44 offen
    s_add_u32 s44, s44, s46
    s_waitcnt vmcnt(14)
    v_lshlrev_b32 v64, 16, v144
    v_and_b32 v65, 0xffff0000, v144
    v_lshlrev_b32 v66, 16, v145
    v_and_b32 v67, 0xffff0000, v145
    v_lshlrev_b32 v68, 16, v146
    v_and_b32 v69, 0xffff0000, v146
    v_lshlrev_b32 v70, 16, v147
    v_and_b32 v71, 0xffff0000, v147
    v_pk_fma_f32 v[72:73], v[64:65], v[36:37], v[72:73] op_sel:[0,0,0] op_sel_hi:[1,0,1]
    v_pk_fma_f32 v[74:75], v[66:67], v[36:37], v[74:75] op_sel:[0,0,0] op_sel_hi:[1,0,1]
    v_pk_fma_f32 v[76:77], v[68:69], v[36:37], v[76:77] op_sel:[0,0,0] op_sel_hi:[1,0,1]
    v_pk_fma_f32 v[78:79], v[70:71], v[36:37], v[78:79] op_sel:[0,0,0] op_sel_hi:[1,0,1]
    buffer_load_dwordx4 v[204:207], v8, s[20:23], s44 offen
    s_add_u32 s44, s44, s46
    s_waitcnt vmcnt(14)
    v_lshlrev_b32 v64, 16, v148
    v_and_b32 v65, 0xffff0000, v148
    v_lshlrev_b32 v66, 16, v149
    v_and_b32 v67, 0xffff0000, v149
    v_lshlrev_b32 v68, 16, v150
    v_and_b32 v69, 0xffff0000, v150
    v_lshlrev_b32 v70, 16, v151
    v_and_b32 v71, 0xffff0000, v151
    v_pk_fma_f32 v[72:73], v[64:65], v[36:37], v[72:73] op_sel:[0,1,0] op_sel_hi:[1,1,1]
    v_pk_fma_f32 v[74:75], v[66:67], v[36:37], v[74:75] op_sel:[0,1,0] op_sel_hi:[1,1,1]
    v_pk_fma_f32 v[76:77], v[68:69], v[36:37], v[76:77] op_sel:[0,1,0] op_sel_hi:[1,1,1]
    v_pk_fma_f32 v[78:79], v[70:71], v[36:37], v[78:79] op_sel:[0,1,0] op_sel_hi:[1,1,1]
    buffer_load_dwordx4 v[208:211], v8, s[20:23], s44 offen
    s_add_u32 s44, s44, s46
    s_waitcnt vmcnt(14)
    v_lshlrev_b32 v64, 16, v152
    v_and_b32 v65, 0xffff0000, v152
    v_lshlrev_b32 v66, 16, v153
    v_and_b32 v67, 0xffff0000, v153
    v_lshlrev_b32 v68, 16, v154
    v_and_b32 v69, 0xffff0000, v154
    v_lshlrev_b32 v70, 16, v155
    v_and_b32 v71, 0xffff0000, v155
    v_pk_fma_f32 v[72:73], v[64:65], v[38:39], v[72:73] op_sel:[0,0,0] op_sel_hi:[1,0,1]
    v_pk_fma_f32 v[74:75], v[66:67], v[38:39], v[74:75] op_sel:[0,0,0] op_sel_hi:[1,0,1]
    v_pk_fma_f32 v[76:77], v[68:69], v[38:39], v[76:77] op_sel:[0,0,0] op_sel_hi:[1,0,1]
    v_pk_fma_f32 v[78:79], v[70:71], v[38:39], v[78:79] op_sel:[0,0,0] op_sel_hi:[1,0,1]
    buffer_load_dwordx4 v[212:215], v8, s[20:23], s44 offen
    s_add_u32 s44, s44, s46
    s_waitcnt vmcnt(14)
    v_lshlrev_b32 v64, 16, v156
    v_and_b32 v65, 0xffff0000, v156
    v_lshlrev_b32 v66, 16, v157
    v_and_b32 v67, 0xffff0000, v157
    v_lshlrev_b32 v68, 16, v158
    v_and_b32 v69, 0xffff0000, v158
    v_lshlrev_b32 v70, 16, v159
    v_and_b32 v71, 0xffff0000, v159
    v_pk_fma_f32 v[72:73], v[64:65], v[38:39], v[72:73] op_sel:[0,1,0] op_sel_hi:[1,1,1]
    v_pk_fma_f32 v[74:75], v[66:67], v[38:39], v[74:75] op_sel:[0,1,0] op_sel_hi:[1,1,1]
    v_pk_fma_f32 v[76:77], v[68:69], v[38:39], v[76:77] op_sel:[0,1,0] op_sel_hi:[1,1,1]
    v_pk_fma_f32 v[78:79], v[70:71], v[38:39], v[78:79] op_sel:[0,1,0] op_sel_hi:[1,1,1]
    buffer_load_dwordx4 v[216:219], v8, s[20:23], s44 offen
    s_add_u32 s44, s44, s46
    s_waitcnt vmcnt(14)
    v_lshlrev_b32 v64, 16, v160
    v_and_b32 v65, 0xffff0000, v160
    v_lshlrev_b32 v66, 16, v161
    v_and_b32 v67, 0xffff0000, v161
    v_lshlrev_b32 v68, 16, v162
    v_and_b32 v69, 0xffff0000, v162
    v_lshlrev_b32 v70, 16, v163
    v_and_b32 v71, 0xffff0000, v163
    v_pk_fma_f32 v[72:73], v[64:65], v[40:41], v[72:73] op_sel:[0,0,0] op_sel_hi:[1,0,1]
    v_pk_fma_f32 v[74:75], v[66:67], v[40:41], v[74:75] op_sel:[0,0,0] op_sel_hi:[1,0,1]
    v_pk_fma_f32 v[76:77], v[68:69], v[40:41], v[76:77] op_sel:[0,0,0] op_sel_hi:[1,0,1]
    v_pk_fma_f32 v[78:79], v[70:71], v[40:41], v[78:79] op_sel:[0,0,0] op_sel_hi:[1,0,1]
    buffer_load_dwordx4 v[220:223], v8, s[20:23], s44 offen
    s_add_u32 s44, s44, s46
    s_waitcnt vmcnt(14)
    v_lshlrev_b32 v64, 16, v164
    v_and_b32 v65, 0xffff0000, v164
    v_lshlrev_b32 v66, 16, v165
    v_and_b32 v67, 0xffff0000, v165
    v_lshlrev_b32 v68, 16, v166
    v_and_b32 v69, 0xffff0000, v166
    v_lshlrev_b32 v70, 16, v167
    v_and_b32 v71, 0xffff0000, v167
    v_pk_fma_f32 v[72:73], v[64:65], v[40:41], v[72:73] op_sel:[0,1,0] op_sel_hi:[1,1,1]
    v_pk_fma_f32 v[74:75], v[66:67], v[40:41], v[74:75] op_sel:[0,1,0] op_sel_hi:[1,1,1]
    v_pk_fma_f32 v[76:77], v[68:69], v[40:41], v[76:77] op_sel:[0,1,0] op_sel_hi:[1,1,1]
    v_pk_fma_f32 v[78:79], v[70:71], v[40:41], v[78:79] op_sel:[0,1,0] op_sel_hi:[1,1,1]
    buffer_load_dwordx4 v[224:227], v8, s[20:23], s44 offen
    s_add_u32 s44, s44, s46
    s_waitcnt vmcnt(14)
    v_lshlrev_b32 v64, 16, v168
    v_and_b32 v65, 0xffff0000, v168
    v_lshlrev_b32 v66, 16, v169
    v_and_b32 v67, 0xffff0000, v169
    v_lshlrev_b32 v68, 16, v170
    v_and_b32 v69, 0xffff0000, v170
    v_lshlrev_b32 v70, 16, v171
    v_and_b32 v71, 0xffff0000, v171
    v_pk_fma_f32 v[72:73], v[64:65], v[42:43], v[72:73] op_sel:[0,0,0] op_sel_hi:[1,0,1]
    v_pk_fma_f32 v[74:75], v[66:67], v[42:43], v[74:75] op_sel:[0,0,0] op_sel_hi:[1,0,1]
    v_pk_fma_f32 v[76:77], v[68:69], v[42:43], v[76:77] op_sel:[0,0,0] op_sel_hi:[1,0,1]
    v_pk_fma_f32 v[78:79], v[70:71], v[42:43], v[78:79] op_sel:[0,0,0] op_sel_hi:[1,0,1]
    buffer_load_dwordx4 v[228:231], v8, s[20:23], s44 offen
    s_add_u32 s44, s44, s46
    s_waitcnt vmcnt(14)
    v_lshlrev_b32 v64, 16, v172
    v_and_b32 v65, 0xffff0000, v172
    v_lshlrev_b32 v66, 16, v173
    v_and_b32 v67, 0xffff0000, v173
    v_lshlrev_b32 v68, 16, v174
    v_and_b32 v69, 0xffff0000, v174
    v_lshlrev_b32 v70, 16, v175
    v_and_b32 v71, 0xffff0000, v175
    v_pk_fma_f32 v[72:73], v[64:65], v[42:43], v[72:73] op_sel:[0,1,0] op_sel_hi:[1,1,1]
    v_pk_fma_f32 v[74:75], v[66:67], v[42:43], v[74:75] op_sel:[0,1,0] op_sel_hi:[1,1,1]
    v_pk_fma_f32 v[76:77], v[68:69], v[42:43], v[76:77] op_sel:[0,1,0] op_sel_hi:[1,1,1]
    v_pk_fma_f32 v[78:79], v[70:71], v[42:43], v[78:79] op_sel:[0,1,0] op_sel_hi:[1,1,1]
    buffer_load_dwordx4 v[232:235], v8, s[20:23], s44 offen
    s_add_u32 s44, s44, s46
    s_waitcnt vmcnt(14)
    v_lshlrev_b32 v64, 16, v176
    v_and_b32 v65, 0xffff0000, v176
    v_lshlrev_b32 v66, 16, v177
    v_and_b32 v67, 0xffff0000, v177
    v_lshlrev_b32 v68, 16, v178
    v_and_b32 v69, 0xffff0000, v178
    v_lshlrev_b32 v70, 16, v179
    v_and_b32 v71, 0xffff0000, v179
    v_pk_fma_f32 v[72:73], v[64:65], v[44:45], v[72:73] op_sel:[0,0,0] op_sel_hi:[1,0,1]
    v_pk_fma_f32 v[74:75], v[66:67], v[44:45], v[74:75] op_sel:[0,0,0] op_sel_hi:[1,0,1]
    v_pk_fma_f32 v[76:77], v[68:69], v[44:45], v[76:77] op_sel:[0,0,0] op_sel_hi:[1,0,1]
    v_pk_fma_f32 v[78:79], v[70:71], v[44:45], v[78:79] op_sel:[0,0,0] op_sel_hi:[1,0,1]
    buffer_load_dwordx4 v[236:239], v8, s[20:23], s44 offen
    s_waitcnt vmcnt(14)
    v_lshlrev_b32 v64, 16, v180
    v_and_b32 v65, 0xffff0000, v180
    v_lshlrev_b32 v66, 16, v181
    v_and_b32 v67, 0xffff0000, v181
    v_lshlrev_b32 v68, 16, v182
    v_and_b32 v69, 0xffff0000, v182
    v_lshlrev_b32 v70, 16, v183
    v_and_b32 v71, 0xffff0000, v183
    v_pk_fma_f32 v[72:73], v[64:65], v[44:45], v[72:73] op_sel:[0,1,0] op_sel_hi:[1,1,1]
    v_pk_fma_f32 v[74:75], v[66:67], v[44:45], v[74:75] op_sel:[0,1,0] op_sel_hi:[1,1,1]
    v_pk_fma_f32 v[76:77], v[68:69], v[44:45], v[76:77] op_sel:[0,1,0] op_sel_hi:[1,1,1]
    v_pk_fma_f32 v[78:79], v[70:71], v[44:45], v[78:79] op_sel:[0,1,0] op_sel_hi:[1,1,1]
    buffer_load_dwordx4 v[112:115], v26, s[24:27], 0 offen
    buffer_load_dwordx4 v[116:119], v27, s[24:27], 0 offen
    s_mov_b32 s66, 6291456
    buffer_store_dwordx4 v[120:123], v28, s[4:7], s66 offen sc1
    buffer_store_dwordx4 v[120:123], v29, s[4:7], s66 offen sc1
    s_waitcnt vmcnt(17)
    v_lshlrev_b32 v64, 16, v184
    v_and_b32 v65, 0xffff0000, v184
    v_lshlrev_b32 v66, 16, v185
    v_and_b32 v67, 0xffff0000, v185
    v_lshlrev_b32 v68, 16, v186
    v_and_b32 v69, 0xffff0000, v186
    v_lshlrev_b32 v70, 16, v187
    v_and_b32 v71, 0xffff0000, v187
    v_pk_fma_f32 v[72:73], v[64:65], v[46:47], v[72:73] op_sel:[0,0,0] op_sel_hi:[1,0,1]
    v_pk_fma_f32 v[74:75], v[66:67], v[46:47], v[74:75] op_sel:[0,0,0] op_sel_hi:[1,0,1]
    v_pk_fma_f32 v[76:77], v[68:69], v[46:47], v[76:77] op_sel:[0,0,0] op_sel_hi:[1,0,1]
    v_pk_fma_f32 v[78:79], v[70:71], v[46:47], v[78:79] op_sel:[0,0,0] op_sel_hi:[1,0,1]
    s_waitcnt vmcnt(16)
    v_lshlrev_b32 v64, 16, v188
    v_and_b32 v65, 0xffff0000, v188
    v_lshlrev_b32 v66, 16, v189
    v_and_b32 v67, 0xffff0000, v189
    v_lshlrev_b32 v68, 16, v190
    v_and_b32 v69, 0xffff0000, v190
    v_lshlrev_b32 v70, 16, v191
    v_and_b32 v71, 0xffff0000, v191
    v_pk_fma_f32 v[72:73], v[64:65], v[46:47], v[72:73] op_sel:[0,1,0] op_sel_hi:[1,1,1]
    v_pk_fma_f32 v[74:75], v[66:67], v[46:47], v[74:75] op_sel:[0,1,0] op_sel_hi:[1,1,1]
    v_pk_fma_f32 v[76:77], v[68:69], v[46:47], v[76:77] op_sel:[0,1,0] op_sel_hi:[1,1,1]
    v_pk_fma_f32 v[78:79], v[70:71], v[46:47], v[78:79] op_sel:[0,1,0] op_sel_hi:[1,1,1]
    s_waitcnt vmcnt(15)
    v_lshlrev_b32 v64, 16, v192
    v_and_b32 v65, 0xffff0000, v192
    v_lshlrev_b32 v66, 16, v193
    v_and_b32 v67, 0xffff0000, v193
    v_lshlrev_b32 v68, 16, v194
    v_and_b32 v69, 0xffff0000, v194
    v_lshlrev_b32 v70, 16, v195
    v_and_b32 v71, 0xffff0000, v195
    v_pk_fma_f32 v[72:73], v[64:65], v[48:49], v[72:73] op_sel:[0,0,0] op_sel_hi:[1,0,1]
    v_pk_fma_f32 v[74:75], v[66:67], v[48:49], v[74:75] op_sel:[0,0,0] op_sel_hi:[1,0,1]
    v_pk_fma_f32 v[76:77], v[68:69], v[48:49], v[76:77] op_sel:[0,0,0] op_sel_hi:[1,0,1]
    v_pk_fma_f32 v[78:79], v[70:71], v[48:49], v[78:79] op_sel:[0,0,0] op_sel_hi:[1,0,1]
    s_waitcnt vmcnt(14)
    v_lshlrev_b32 v64, 16, v196
    v_and_b32 v65, 0xffff0000, v196
    v_lshlrev_b32 v66, 16, v197
    v_and_b32 v67, 0xffff0000, v197
    v_lshlrev_b32 v68, 16, v198
    v_and_b32 v69, 0xffff0000, v198
    v_lshlrev_b32 v70, 16, v199
    v_and_b32 v71, 0xffff0000, v199
    v_pk_fma_f32 v[72:73], v[64:65], v[48:49], v[72:73] op_sel:[0,1,0] op_sel_hi:[1,1,1]
    v_pk_fma_f32 v[74:75], v[66:67], v[48:49], v[74:75] op_sel:[0,1,0] op_sel_hi:[1,1,1]
    v_pk_fma_f32 v[76:77], v[68:69], v[48:49], v[76:77] op_sel:[0,1,0] op_sel_hi:[1,1,1]
    v_pk_fma_f32 v[78:79], v[70:71], v[48:49], v[78:79] op_sel:[0,1,0] op_sel_hi:[1,1,1]
    s_waitcnt vmcnt(13)
    v_lshlrev_b32 v64, 16, v200
    v_and_b32 v65, 0xffff0000, v200
    v_lshlrev_b32 v66, 16, v201
    v_and_b32 v67, 0xffff0000, v201
    v_lshlrev_b32 v68, 16, v202
    v_and_b32 v69, 0xffff0000, v202
    v_lshlrev_b32 v70, 16, v203
    v_and_b32 v71, 0xffff0000, v203
    v_pk_fma_f32 v[72:73], v[64:65], v[50:51], v[72:73] op_sel:[0,0,0] op_sel_hi:[1,0,1]
    v_pk_fma_f32 v[74:75], v[66:67], v[50:51], v[74:75] op_sel:[0,0,0] op_sel_hi:[1,0,1]
    v_pk_fma_f32 v[76:77], v[68:69], v[50:51], v[76:77] op_sel:[0,0,0] op_sel_hi:[1,0,1]
    v_pk_fma_f32 v[78:79], v[70:71], v[50:51], v[78:79] op_sel:[0,0,0] op_sel_hi:[1,0,1]
    s_waitcnt vmcnt(12)
    v_lshlrev_b32 v64, 16, v204
    v_and_b32 v65, 0xffff0000, v204
    v_lshlrev_b32 v66, 16, v205
    v_and_b32 v67, 0xffff0000, v205
    v_lshlrev_b32 v68, 16, v206
    v_and_b32 v69, 0xffff0000, v206
    v_lshlrev_b32 v70, 16, v207
    v_and_b32 v71, 0xffff0000, v207
    v_pk_fma_f32 v[72:73], v[64:65], v[50:51], v[72:73] op_sel:[0,1,0] op_sel_hi:[1,1,1]
    v_pk_fma_f32 v[74:75], v[66:67], v[50:51], v[74:75] op_sel:[0,1,0] op_sel_hi:[1,1,1]
    v_pk_fma_f32 v[76:77], v[68:69], v[50:51], v[76:77] op_sel:[0,1,0] op_sel_hi:[1,1,1]
    v_pk_fma_f32 v[78:79], v[70:71], v[50:51], v[78:79] op_sel:[0,1,0] op_sel_hi:[1,1,1]
    s_waitcnt vmcnt(11)
    v_lshlrev_b32 v64, 16, v208
    v_and_b32 v65, 0xffff0000, v208
    v_lshlrev_b32 v66, 16, v209
    v_and_b32 v67, 0xffff0000, v209
    v_lshlrev_b32 v68, 16, v210
    v_and_b32 v69, 0xffff0000, v210
    v_lshlrev_b32 v70, 16, v211
    v_and_b32 v71, 0xffff0000, v211
    v_pk_fma_f32 v[72:73], v[64:65], v[52:53], v[72:73] op_sel:[0,0,0] op_sel_hi:[1,0,1]
    v_pk_fma_f32 v[74:75], v[66:67], v[52:53], v[74:75] op_sel:[0,0,0] op_sel_hi:[1,0,1]
    v_pk_fma_f32 v[76:77], v[68:69], v[52:53], v[76:77] op_sel:[0,0,0] op_sel_hi:[1,0,1]
    v_pk_fma_f32 v[78:79], v[70:71], v[52:53], v[78:79] op_sel:[0,0,0] op_sel_hi:[1,0,1]
    s_waitcnt vmcnt(10)
    v_lshlrev_b32 v64, 16, v212
    v_and_b32 v65, 0xffff0000, v212
    v_lshlrev_b32 v66, 16, v213
    v_and_b32 v67, 0xffff0000, v213
    v_lshlrev_b32 v68, 16, v214
    v_and_b32 v69, 0xffff0000, v214
    v_lshlrev_b32 v70, 16, v215
    v_and_b32 v71, 0xffff0000, v215
    v_pk_fma_f32 v[72:73], v[64:65], v[52:53], v[72:73] op_sel:[0,1,0] op_sel_hi:[1,1,1]
    v_pk_fma_f32 v[74:75], v[66:67], v[52:53], v[74:75] op_sel:[0,1,0] op_sel_hi:[1,1,1]
    v_pk_fma_f32 v[76:77], v[68:69], v[52:53], v[76:77] op_sel:[0,1,0] op_sel_hi:[1,1,1]
    v_pk_fma_f32 v[78:79], v[70:71], v[52:53], v[78:79] op_sel:[0,1,0] op_sel_hi:[1,1,1]
    s_waitcnt vmcnt(9)
    v_lshlrev_b32 v64, 16, v216
    v_and_b32 v65, 0xffff0000, v216
    v_lshlrev_b32 v66, 16, v217
    v_and_b32 v67, 0xffff0000, v217
    v_lshlrev_b32 v68, 16, v218
    v_and_b32 v69, 0xffff0000, v218
    v_lshlrev_b32 v70, 16, v219
    v_and_b32 v71, 0xffff0000, v219
    v_pk_fma_f32 v[72:73], v[64:65], v[54:55], v[72:73] op_sel:[0,0,0] op_sel_hi:[1,0,1]
    v_pk_fma_f32 v[74:75], v[66:67], v[54:55], v[74:75] op_sel:[0,0,0] op_sel_hi:[1,0,1]
    v_pk_fma_f32 v[76:77], v[68:69], v[54:55], v[76:77] op_sel:[0,0,0] op_sel_hi:[1,0,1]
    v_pk_fma_f32 v[78:79], v[70:71], v[54:55], v[78:79] op_sel:[0,0,0] op_sel_hi:[1,0,1]
    s_waitcnt vmcnt(8)
    v_lshlrev_b32 v64, 16, v220
    v_and_b32 v65, 0xffff0000, v220
    v_lshlrev_b32 v66, 16, v221
    v_and_b32 v67, 0xffff0000, v221
    v_lshlrev_b32 v68, 16, v222
    v_and_b32 v69, 0xffff0000, v222
    v_lshlrev_b32 v70, 16, v223
    v_and_b32 v71, 0xffff0000, v223
    v_pk_fma_f32 v[72:73], v[64:65], v[54:55], v[72:73] op_sel:[0,1,0] op_sel_hi:[1,1,1]
    v_pk_fma_f32 v[74:75], v[66:67], v[54:55], v[74:75] op_sel:[0,1,0] op_sel_hi:[1,1,1]
    v_pk_fma_f32 v[76:77], v[68:69], v[54:55], v[76:77] op_sel:[0,1,0] op_sel_hi:[1,1,1]
    v_pk_fma_f32 v[78:79], v[70:71], v[54:55], v[78:79] op_sel:[0,1,0] op_sel_hi:[1,1,1]
    s_waitcnt vmcnt(7)
    v_lshlrev_b32 v64, 16, v224
    v_and_b32 v65, 0xffff0000, v224
    v_lshlrev_b32 v66, 16, v225
    v_and_b32 v67, 0xffff0000, v225
    v_lshlrev_b32 v68, 16, v226
    v_and_b32 v69, 0xffff0000, v226
    v_lshlrev_b32 v70, 16, v227
    v_and_b32 v71, 0xffff0000, v227
    v_pk_fma_f32 v[72:73], v[64:65], v[56:57], v[72:73] op_sel:[0,0,0] op_sel_hi:[1,0,1]
    v_pk_fma_f32 v[74:75], v[66:67], v[56:57], v[74:75] op_sel:[0,0,0] op_sel_hi:[1,0,1]
    v_pk_fma_f32 v[76:77], v[68:69], v[56:57], v[76:77] op_sel:[0,0,0] op_sel_hi:[1,0,1]
    v_pk_fma_f32 v[78:79], v[70:71], v[56:57], v[78:79] op_sel:[0,0,0] op_sel_hi:[1,0,1]
    s_waitcnt vmcnt(6)
    v_lshlrev_b32 v64, 16, v228
    v_and_b32 v65, 0xffff0000, v228
    v_lshlrev_b32 v66, 16, v229
    v_and_b32 v67, 0xffff0000, v229
    v_lshlrev_b32 v68, 16, v230
    v_and_b32 v69, 0xffff0000, v230
    v_lshlrev_b32 v70, 16, v231
    v_and_b32 v71, 0xffff0000, v231
    v_pk_fma_f32 v[72:73], v[64:65], v[56:57], v[72:73] op_sel:[0,1,0] op_sel_hi:[1,1,1]
    v_pk_fma_f32 v[74:75], v[66:67], v[56:57], v[74:75] op_sel:[0,1,0] op_sel_hi:[1,1,1]
    v_pk_fma_f32 v[76:77], v[68:69], v[56:57], v[76:77] op_sel:[0,1,0] op_sel_hi:[1,1,1]
    v_pk_fma_f32 v[78:79], v[70:71], v[56:57], v[78:79] op_sel:[0,1,0] op_sel_hi:[1,1,1]
    s_waitcnt vmcnt(5)
    v_lshlrev_b32 v64, 16, v232
    v_and_b32 v65, 0xffff0000, v232
    v_lshlrev_b32 v66, 16, v233
    v_and_b32 v67, 0xffff0000, v233
    v_lshlrev_b32 v68, 16, v234
    v_and_b32 v69, 0xffff0000, v234
    v_lshlrev_b32 v70, 16, v235
    v_and_b32 v71, 0xffff0000, v235
    v_pk_fma_f32 v[72:73], v[64:65], v[58:59], v[72:73] op_sel:[0,0,0] op_sel_hi:[1,0,1]
    v_pk_fma_f32 v[74:75], v[66:67], v[58:59], v[74:75] op_sel:[0,0,0] op_sel_hi:[1,0,1]
    v_pk_fma_f32 v[76:77], v[68:69], v[58:59], v[76:77] op_sel:[0,0,0] op_sel_hi:[1,0,1]
    v_pk_fma_f32 v[78:79], v[70:71], v[58:59], v[78:79] op_sel:[0,0,0] op_sel_hi:[1,0,1]
    s_waitcnt vmcnt(4)
    v_lshlrev_b32 v64, 16, v236
    v_and_b32 v65, 0xffff0000, v236
    v_lshlrev_b32 v66, 16, v237
    v_and_b32 v67, 0xffff0000, v237
    v_lshlrev_b32 v68, 16, v238
    v_and_b32 v69, 0xffff0000, v238
    v_lshlrev_b32 v70, 16, v239
    v_and_b32 v71, 0xffff0000, v239
    v_pk_fma_f32 v[72:73], v[64:65], v[58:59], v[72:73] op_sel:[0,1,0] op_sel_hi:[1,1,1]
    v_pk_fma_f32 v[74:75], v[66:67], v[58:59], v[74:75] op_sel:[0,1,0] op_sel_hi:[1,1,1]
    v_pk_fma_f32 v[76:77], v[68:69], v[58:59], v[76:77] op_sel:[0,1,0] op_sel_hi:[1,1,1]
    v_pk_fma_f32 v[78:79], v[70:71], v[58:59], v[78:79] op_sel:[0,1,0] op_sel_hi:[1,1,1]
    v_lshlrev_b32 v12, 5, v0
    ds_write_b128 v12, v[72:75] offset:4096
    ds_write_b128 v12, v[76:79] offset:4112
    v_lshlrev_b32 v13, 2, v1
    v_lshlrev_b32 v12, 3, v1
    s_waitcnt lgkmcnt(0)
    s_barrier
    s_cmp_lg_u32 s3, 0
    s_cbranch_scc1 L_h_rows
    ds_read_b64 v[32:33], v12 offset:4096
    ds_read_b64 v[34:35], v12 offset:4608
    ds_read_b64 v[36:37], v12 offset:5120
    ds_read_b64 v[38:39], v12 offset:5632
    ds_read_b64 v[40:41], v12 offset:6144
    ds_read_b64 v[42:43], v12 offset:6656
    ds_read_b64 v[44:45], v12 offset:7168
    ds_read_b64 v[46:47], v12 offset:7680
    ds_read_b64 v[48:49], v12 offset:8192
    ds_read_b64 v[50:51], v12 offset:8704
    ds_read_b64 v[52:53], v12 offset:9216
    ds_read_b64 v[54:55], v12 offset:9728
    ds_read_b64 v[56:57], v12 offset:10240
    ds_read_b64 v[58:59], v12 offset:10752
    ds_read_b64 v[60:61], v12 offset:11264
    ds_read_b64 v[62:63], v12 offset:11776
    v_add_u32 v9, s49, v13
    v_subrev_u32 v10, 896, v9
    v_cmp_gt_u32 vcc, 896, v10
    v_subrev_u32 v10, 3584, v9
    v_mov_b32 v9, 896
    v_cmp_gt_u32 s[58:59], v9, v10
    s_or_b64 vcc, vcc, s[58:59]
    v_cndmask_b32 v9, 0, 1.0, vcc
    s_waitcnt lgkmcnt(0)
    v_pk_add_f32 v[32:33], v[32:33], v[48:49]
    v_pk_add_f32 v[34:35], v[34:35], v[50:51]
    v_pk_add_f32 v[36:37], v[36:37], v[52:53]
    v_pk_add_f32 v[38:39], v[38:39], v[54:55]
    v_pk_add_f32 v[40:41], v[40:41], v[56:57]
    v_pk_add_f32 v[42:43], v[42:43], v[58:59]
    v_pk_add_f32 v[44:45], v[44:45], v[60:61]
    v_pk_add_f32 v[46:47], v[46:47], v[62:63]
    v_pk_add_f32 v[32:33], v[32:33], v[40:41]
    v_pk_add_f32 v[34:35], v[34:35], v[42:43]
    v_pk_add_f32 v[36:37], v[36:37], v[44:45]
    v_pk_add_f32 v[38:39], v[38:39], v[46:47]
    v_pk_add_f32 v[32:33], v[32:33], v[36:37]
    v_pk_add_f32 v[34:35], v[34:35], v[38:39]
    v_pk_add_f32 v[32:33], v[32:33], v[34:35]
    v_cvt_pk_bf16_f32 v34, v32, v33
    v_lshlrev_b32 v32, 16, v34
    v_and_b32 v33, 0xffff0000, v34
    v_add_f32 v32, v32, v9
    v_add_f32 v33, v33, v9
    v_cvt_pk_bf16_f32 v35, v32, v33
    v_lshlrev_b32 v32, 16, v35
    v_and_b32 v33, 0xffff0000, v35
    v_bfe_u32 v9, v1, 1, 1
    v_lshrrev_b32 v10, 5, v1
    v_xor_b32 v9, v9, v10
    v_lshlrev_b32 v12, 8, v10
    v_lshl_add_u32 v12, v9, 7, v12
    v_bfe_u32 v9, v1, 2, 3
    v_lshl_add_u32 v12, v9, 4, v12
    v_and_b32 v9, 1, v1
    v_lshl_add_u32 v12, v9, 3, v12
    s_lshl_b32 s57, s48, 1
    v_add_u32 v9, s57, v10
    v_mul_u32_u24 v9, 37, v9
    v_lshrrev_b32 v9, 8, v9
    v_lshl_add_u32 v12, v9, 8, v12
    s_lshl_b32 s57, s49, 1
    s_add_u32 s57, s57, 49152
    s_add_u32 s58, s49, 65536
    buffer_store_dwordx2 v[32:33], v12, s[4:7], s57 offen sc1
    buffer_store_dword v34, v13, s[4:7], s58 offen sc1
    s_branch L_h_rows
L_h_free:
    v_lshlrev_b32 v11, 4, v1
    s_mov_b64 s[24:25], s[56:57]
    s_mov_b64 s[28:29], s[70:71]
    s_mov_b64 s[32:33], s[72:73]
    s_mov_b64 s[36:37], s[74:75]
    s_mov_b32 s26, 1835008
    s_mov_b32 s27, s7
    s_mov_b32 s30, 1605632
    s_mov_b32 s31, s7
    s_mov_b32 s34, s30
    s_mov_b32 s35, s7
    s_mov_b32 s38, s30
    s_mov_b32 s39, s7
    s_mov_b32 s42, s26
    s_mov_b32 s43, s7
    s_and_b32 s57, s53, 7
    s_lshl_b32 s57, s57, 5
    s_and_b32 s58, s53, 24
    s_add_u32 s57, s57, s58
    s_lshl_b32 s58, s52, 8
    s_add_u32 s57, s57, s58
    s_lshr_b32 s58, s3, 1
    s_add_u32 s57, s57, s58
    s_and_b32 s58, s3, 1
    s_lshl_b32 s58, s58, 2
    s_add_u32 s57, s57, s58
    v_lshrrev_b32 v2, 5, v1
    v_lshl_add_u32 v2, v2, 1, s57
    v_and_b32 v24, 31, v1
    v_bfe_u32 v25, v2, 1, 3
    v_mul_u32_u24 v2, 896, v2
    v_xor_b32 v25, v25, v24
    v_lshl_add_u32 v26, v24, 4, v2
    v_lshl_add_u32 v28, v25, 4, v2
    v_cmp_gt_u32 vcc, 24, v24
    v_mov_b32 v25, 0x80000000
    v_add_u32 v27, 512, v26
    v_add_u32 v29, 512, v28
    v_cndmask_b32 v27, v25, v27, vcc
    v_cndmask_b32 v29, v25, v29, vcc
    s_mov_b32 s6, 18874368
    v_mov_b32 v120, -1
    v_mov_b32 v121, -1
    v_mov_b32 v122, -1
    v_mov_b32 v123, -1
    v_mov_b32 v20, 0x80000000
    v_mov_b32 v21, 0
    v_mov_b32 v22, 0
    s_mov_b32 s60, 0
    s_mov_b32 s1, 0
    s_mov_b32 s14, 0
    s_mov_b32 s15, 0
    s_and_b32 s57, s3, 1
    s_cmp_eq_u32 s57, 0
    s_cselect_b32 s8, s28, s32
    s_cselect_b32 s9, s29, s33
    s_mov_b32 s10, s30
    s_mov_b32 s11, s7
    v_lshrrev_b32 v16, 4, v1
    v_mul_u32_u24 v16, 112, v16
    v_and_b32 v17, 15, v1
    v_min_u32 v17, 13, v17
    v_add_lshl_u32 v16, v16, v17, 7
    s_lshr_b32 s57, s52, 1
    s_mul_i32 s57, s57, 3584
    s_and_b32 s58, s52, 1
    s_mul_i32 s58, s58, 1792
    s_add_u32 s45, s57, s58
    buffer_load_dwordx4 v[112:115], v26, s[24:27], 0 offen
    buffer_load_dwordx4 v[116:119], v27, s[24:27], 0 offen
    s_mov_b32 s66, 6291456
    buffer_store_dwordx4 v[120:123], v28, s[4:7], s66 offen sc1
    buffer_store_dwordx4 v[120:123], v29, s[4:7], s66 offen sc1
    s_cmp_lg_u32 s53, 31
    s_cbranch_scc1 L_h_rows
    s_mul_i32 s57, s3, 43008
    s_lshl_b32 s58, s52, 8
    s_add_u32 s57, s57, s58
    s_add_u32 s57, s57, 1720320
    s_cmp_lt_u32 s52, 5
    s_cselect_b32 s58, 2, 1
    v_lshrrev_b32 v18, 3, v1
    v_mul_u32_u24 v18, 42, v18
    v_bfe_u32 v19, v1, 1, 2
    v_min_u32 v19, s58, v19
    v_lshl_add_u32 v18, v19, 4, v18
    v_and_b32 v19, 1, v1
    v_add_lshl_u32 v18, v18, v19, 7
    buffer_load_dword v128, v18, s[20:23], s57 offen
    s_add_u32 s57, s57, 172032
    buffer_load_dword v129, v18, s[20:23], s57 offen
    s_add_u32 s57, s57, 172032
    buffer_load_dword v130, v18, s[20:23], s57 offen
    s_add_u32 s57, s57, 172032
    buffer_load_dword v131, v18, s[20:23], s57 offen
L_h_rows:
    s_waitcnt vmcnt(0) lgkmcnt(0)
    s_barrier
    s_add_u32 s50, s50, 1
    s_addc_u32 s51, s51, 0
    v_mov_b32 v124, s50
    v_mov_b32 v125, s51
    s_lshl_b32 s57, s2, 5
    s_add_u32 s57, s57, 393216
    s_cmp_eq_u32 s3, 0
    s_cselect_b32 s57, s57, 0x80000000
    v_add_u32 v14, s57, v11
    s_mov_b64 exec, 1
    buffer_store_dwordx2 v[124:125], v14, s[4:7], 0 offen sc1
    s_mov_b64 exec, -1
    s_mul_i32 s57, s3, 49
    s_add_u32 s57, s57, s48
    s_lshl_b32 s57, s57, 13
    v_lshlrev_b32 v2, 7, v1
    buffer_load_dword v132, v2, s[36:39], s57 offen
    s_lshl2_add_u32 s57, s48, s3
    s_sub_u32 s57, s57, 84
    s_cmp_lt_u32 s57, 8
    s_cbranch_scc0 L_h_ln2
    s_lshl_b32 s57, s57, 13
    s_add_u32 s57, s57, 98304
    buffer_load_dword v137, v2, s[4:7], s57 offen
L_h_ln2:
    s_mul_i32 s57, s3, 49
    s_add_u32 s57, s57, s48
    s_add_u32 s57, s57, 17
    s_lshl_b32 s57, s57, 13
    s_cmp_ge_u32 s48, 15
    s_cselect_b32 s57, s57, 0x80000000
    v_lshlrev_b32 v2, 7, v1
    buffer_load_dword v133, v2, s[36:39], s57 offen
    v_lshlrev_b32 v64, 16, v112
    v_and_b32 v65, 0xffff0000, v112
    v_lshlrev_b32 v66, 16, v113
    v_and_b32 v67, 0xffff0000, v113
    v_lshlrev_b32 v68, 16, v114
    v_and_b32 v69, 0xffff0000, v114
    v_lshlrev_b32 v70, 16, v115
    v_and_b32 v71, 0xffff0000, v115
    v_lshlrev_b32 v72, 16, v116
    v_and_b32 v73, 0xffff0000, v116
    v_lshlrev_b32 v74, 16, v117
    v_and_b32 v75, 0xffff0000, v117
    v_lshlrev_b32 v76, 16, v118
    v_and_b32 v77, 0xffff0000, v118
    v_lshlrev_b32 v78, 16, v119
    v_and_b32 v79, 0xffff0000, v119
    v_pk_add_f32 v[6:7], v[64:65], v[66:67]
    v_pk_mul_f32 v[80:81], v[64:65], v[64:65]
    v_pk_fma_f32 v[80:81], v[66:67], v[66:67], v[80:81]
    v_pk_add_f32 v[6:7], v[6:7], v[68:69]
    v_pk_fma_f32 v[80:81], v[68:69], v[68:69], v[80:81]
    v_pk_add_f32 v[6:7], v[6:7], v[70:71]
    v_pk_fma_f32 v[80:81], v[70:71], v[70:71], v[80:81]
    v_pk_add_f32 v[6:7], v[6:7], v[72:73]
    v_pk_fma_f32 v[80:81], v[72:73], v[72:73], v[80:81]
    v_pk_add_f32 v[6:7], v[6:7], v[74:75]
    v_pk_fma_f32 v[80:81], v[74:75], v[74:75], v[80:81]
    v_pk_add_f32 v[6:7], v[6:7], v[76:77]
    v_pk_fma_f32 v[80:81], v[76:77], v[76:77], v[80:81]
    v_pk_add_f32 v[6:7], v[6:7], v[78:79]
    v_pk_fma_f32 v[80:81], v[78:79], v[78:79], v[80:81]
    v_add_f32 v6, v6, v7
    v_add_f32 v80, v80, v81
    s_nop 1
    v_permlane16_swap_b32 v6, v80
    v_add_f32 v6, v6, v80
    s_nop 1
    v_add_f32_dpp v6, v6, v6 quad_perm:[1,0,3,2] row_mask:0xf bank_mask:0xf
    s_nop 1
    v_add_f32_dpp v6, v6, v6 quad_perm:[2,3,0,1] row_mask:0xf bank_mask:0xf
    s_nop 1
    v_add_f32_dpp v6, v6, v6 row_half_mirror row_mask:0xf bank_mask:0xf
    s_nop 1
    v_add_f32_dpp v6, v6, v6 row_mirror row_mask:0xf bank_mask:0xf
    v_mul_f32 v7, 0x3b124925, v6
    v_mul_f32 v80, 0x3b124925, v6
    s_nop 1
    v_permlane16_swap_b32 v7, v80
    v_fma_f32 v80, -v7, v7, v80
    v_max_f32 v80, 0, v80
    v_add_f32 v80, 0x3727c5ac, v80
    v_rsq_f32 v6, v80
    s_nop 0
    v_mul_f32_e64 v7, -v7, v6
    v_lshlrev_b32 v14, 5, v0
    v_add_u32 v14, 393216, v14
    buffer_load_dwordx2 v[126:127], v14, s[4:7], 0 offen sc1
    s_waitcnt vmcnt(0)
    s_mov_b32 s67, 0
L_h_fb:
    v_cmp_ne_u64 vcc, s[50:51], v[126:127]
    s_cbranch_vccz L_h_fbok
    s_sleep 8
    buffer_load_dwordx2 v[126:127], v14, s[4:7], 0 offen sc1
    s_waitcnt vmcnt(0)
    s_add_u32 s67, s67, 1
    s_cmp_lt_u32 s67, 65536
    s_cbranch_scc1 L_h_fb
L_h_fbok:
    s_branch L_stageB
L_yy_retry:
    s_mov_b32 s67, 0
L_yy_loop:
    s_sleep 4
    buffer_load_dwordx4 v[104:107], v13, s[4:7], s62 offen sc1
    buffer_load_dwordx4 v[108:111], v13, s[4:7], s63 offen sc1
    s_waitcnt vmcnt(0) lgkmcnt(0)
    v_bitop3_b32 v15, v104, v105, v106 bitop3:0x80
    v_bitop3_b32 v15, v15, v107, v108 bitop3:0x80
    v_bitop3_b32 v15, v15, v109, v110 bitop3:0x80
    v_bitop3_b32 v15, v15, v111, 1 bitop3:0x80
    v_cmp_eq_u32 vcc, 0, v15
    s_cbranch_vccz L_yy_ok
    s_add_u32 s67, s67, 1
    s_cmp_lt_u32 s67, 65536
    s_cbranch_scc1 L_yy_loop
    s_branch L_yy_ok
L_h_done:
    buffer_store_dwordx4 v[112:115], v26, s[4:7], s49 offen sc1
    buffer_store_dwordx4 v[116:119], v27, s[4:7], s49 offen sc1
    s_lshr_b32 s57, s48, 1
    s_lshl_b32 s57, s57, 2
    s_and_b32 s58, s48, 1
    s_mul_i32 s57, s57, 114688
    s_lshl2_add_u32 s58, s58, s3
    s_mul_i32 s58, s58, 28672
    s_add_u32 s57, s57, s58
    s_add_u32 s57, s57, 10715136
    buffer_store_dwordx4 v[120:123], v11, s[4:7], s57 offen offset:0 sc1
    buffer_store_dwordx4 v[120:123], v11, s[4:7], s57 offen offset:1024 sc1
    buffer_store_dwordx4 v[120:123], v11, s[4:7], s57 offen offset:2048 sc1
    buffer_store_dwordx4 v[120:123], v11, s[4:7], s57 offen offset:3072 sc1
    s_add_u32 s57, s57, 4096
    buffer_store_dwordx4 v[120:123], v11, s[4:7], s57 offen offset:0 sc1
    buffer_store_dwordx4 v[120:123], v11, s[4:7], s57 offen offset:1024 sc1
    buffer_store_dwordx4 v[120:123], v11, s[4:7], s57 offen offset:2048 sc1
    buffer_store_dwordx4 v[120:123], v11, s[4:7], s57 offen offset:3072 sc1
    s_add_u32 s57, s57, 4096
    buffer_store_dwordx4 v[120:123], v11, s[4:7], s57 offen offset:0 sc1
    s_waitcnt vmcnt(9)
    s_mov_b64 exec, 1
    buffer_store_dwordx2 v[6:7], v8, s[4:7], 0 offen sc1
    s_mov_b64 exec, -1
    buffer_store_dwordx4 v[120:123], v11, s[4:7], s57 offen offset:1024 sc1
    buffer_store_dwordx4 v[120:123], v11, s[4:7], s57 offen offset:2048 sc1
    buffer_store_dwordx4 v[120:123], v11, s[4:7], s57 offen offset:3072 sc1
    s_add_u32 s57, s57, 4096
    buffer_store_dwordx4 v[120:123], v11, s[4:7], s57 offen offset:0 sc1
    buffer_store_dwordx4 v[120:123], v11, s[4:7], s57 offen offset:1024 sc1
    buffer_store_dwordx4 v[120:123], v11, s[4:7], s57 offen offset:2048 sc1
    buffer_store_dwordx4 v[120:123], v11, s[4:7], s57 offen offset:3072 sc1
    s_add_u32 s57, s57, 4096
    buffer_store_dwordx4 v[120:123], v11, s[4:7], s57 offen offset:0 sc1
    buffer_store_dwordx4 v[120:123], v11, s[4:7], s57 offen offset:1024 sc1
    buffer_store_dwordx4 v[120:123], v11, s[4:7], s57 offen offset:2048 sc1
    buffer_store_dwordx4 v[120:123], v11, s[4:7], s57 offen offset:3072 sc1
    s_add_u32 s57, s57, 4096
    buffer_store_dwordx4 v[120:123], v11, s[4:7], s57 offen offset:0 sc1
    buffer_store_dwordx4 v[120:123], v11, s[4:7], s57 offen offset:1024 sc1
    buffer_store_dwordx4 v[120:123], v11, s[4:7], s57 offen offset:2048 sc1
    buffer_store_dwordx4 v[120:123], v11, s[4:7], s57 offen offset:3072 sc1
    s_add_u32 s57, s57, 4096
    buffer_store_dwordx4 v[120:123], v11, s[4:7], s57 offen offset:0 sc1
    buffer_store_dwordx4 v[120:123], v11, s[4:7], s57 offen offset:1024 sc1
    buffer_store_dwordx4 v[120:123], v11, s[4:7], s57 offen offset:2048 sc1
    buffer_store_dwordx4 v[120:123], v11, s[4:7], s57 offen offset:3072 sc1
    s_add_u32 s57, s57, 4096
    s_lshl_b32 s57, s48, 5
    s_add_u32 s57, s57, 73728
    s_cmp_eq_u32 s3, 0
    s_cselect_b32 s57, s57, 0x80000000
    v_mov_b32 v8, s57
    s_waitcnt vmcnt(0)
    s_barrier
    s_mov_b64 exec, 1
    buffer_store_dwordx2 v[6:7], v8, s[4:7], 0 offen sc1
    s_mov_b64 exec, -1
    s_cmp_lg_u32 s2, 255
    s_cbranch_scc1 L_exit
    v_mov_b32 v8, 0
    s_mov_b64 exec, 1
    buffer_store_dwordx2 v[6:7], v8, s[4:7], 0 offen sc1
    s_mov_b64 exec, -1
    s_branch L_exit
L_h0_retry:
    s_mov_b32 s67, 0
L_h0_loop:
    s_mov_b32 s44, m0
    s_add_u32 m0, s63, 0
    s_add_u32 s57, s62, 0
    buffer_load_dwordx4 v11, s[4:7], s57 offen offset:0 sc1 lds
    buffer_load_dwordx4 v11, s[4:7], s57 offen offset:1024 sc1 lds
    buffer_load_dwordx4 v11, s[4:7], s57 offen offset:2048 sc1 lds
    buffer_load_dwordx4 v11, s[4:7], s57 offen offset:3072 sc1 lds
    s_add_u32 m0, s63, 4096
    s_add_u32 s57, s62, 4096
    buffer_load_dwordx4 v11, s[4:7], s57 offen offset:0 sc1 lds
    buffer_load_dwordx4 v11, s[4:7], s57 offen offset:1024 sc1 lds
    buffer_load_dwordx4 v11, s[4:7], s57 offen offset:2048 sc1 lds
    s_mov_b32 m0, s44
    s_waitcnt vmcnt(0) lgkmcnt(0)
    ds_read_b128 v[224:227], v2 offset:0
    ds_read_b128 v[228:231], v2 offset:1024
    ds_read_b128 v[232:235], v2 offset:2048
    ds_read_b128 v[236:239], v2 offset:3072
    ds_read_b128 v[240:243], v2 offset:4096
    ds_read_b128 v[244:247], v2 offset:5120
    ds_read_b128 v[248:251], v2 offset:6144
    s_waitcnt lgkmcnt(0)
    v_max3_u32 v10, v224, v225, v226
    v_max_u32 v10, v10, v227
    s_waitcnt lgkmcnt(0)
    v_max3_u32 v10, v10, v228, v229
    v_max3_u32 v10, v10, v230, v231
    s_waitcnt lgkmcnt(0)
    v_max3_u32 v10, v10, v232, v233
    v_max3_u32 v10, v10, v234, v235
    s_waitcnt lgkmcnt(0)
    v_max3_u32 v10, v10, v236, v237
    v_max3_u32 v10, v10, v238, v239
    s_waitcnt lgkmcnt(0)
    v_max3_u32 v10, v10, v240, v241
    v_max3_u32 v10, v10, v242, v243
    s_waitcnt lgkmcnt(0)
    v_max3_u32 v10, v10, v244, v245
    v_max3_u32 v10, v10, v246, v247
    s_waitcnt lgkmcnt(0)
    v_max3_u32 v10, v10, v248, v249
    v_max3_u32 v10, v10, v250, v251
    v_cmp_eq_u32 vcc, -1, v10
    s_cbranch_vccz L_h0_ok
    s_add_u32 s67, s67, 1
    s_cmp_lt_u32 s67, 65536
    s_cbranch_scc1 L_h0_loop
    s_branch L_h0_ok
L_h1_retry:
    s_mov_b32 s67, 0
L_h1_loop:
    s_mov_b32 s44, m0
    s_add_u32 m0, s63, 28672
    s_add_u32 s57, s62, 28672
    buffer_load_dwordx4 v11, s[4:7], s57 offen offset:0 sc1 lds
    buffer_load_dwordx4 v11, s[4:7], s57 offen offset:1024 sc1 lds
    buffer_load_dwordx4 v11, s[4:7], s57 offen offset:2048 sc1 lds
    buffer_load_dwordx4 v11, s[4:7], s57 offen offset:3072 sc1 lds
    s_add_u32 m0, s63, 32768
    s_add_u32 s57, s62, 32768
    buffer_load_dwordx4 v11, s[4:7], s57 offen offset:0 sc1 lds
    buffer_load_dwordx4 v11, s[4:7], s57 offen offset:1024 sc1 lds
    buffer_load_dwordx4 v11, s[4:7], s57 offen offset:2048 sc1 lds
    s_mov_b32 m0, s44
    s_waitcnt vmcnt(0) lgkmcnt(0)
    ds_read_b128 v[224:227], v2 offset:28672
    ds_read_b128 v[228:231], v2 offset:29696
    ds_read_b128 v[232:235], v2 offset:30720
    ds_read_b128 v[236:239], v2 offset:31744
    ds_read_b128 v[240:243], v2 offset:32768
    ds_read_b128 v[244:247], v2 offset:33792
    ds_read_b128 v[248:251], v2 offset:34816
    s_waitcnt lgkmcnt(0)
    v_max3_u32 v10, v224, v225, v226
    v_max_u32 v10, v10, v227
    s_waitcnt lgkmcnt(0)
    v_max3_u32 v10, v10, v228, v229
    v_max3_u32 v10, v10, v230, v231
    s_waitcnt lgkmcnt(0)
    v_max3_u32 v10, v10, v232, v233
    v_max3_u32 v10, v10, v234, v235
    s_waitcnt lgkmcnt(0)
    v_max3_u32 v10, v10, v236, v237
    v_max3_u32 v10, v10, v238, v239
    s_waitcnt lgkmcnt(0)
    v_max3_u32 v10, v10, v240, v241
    v_max3_u32 v10, v10, v242, v243
    s_waitcnt lgkmcnt(0)
    v_max3_u32 v10, v10, v244, v245
    v_max3_u32 v10, v10, v246, v247
    s_waitcnt lgkmcnt(0)
    v_max3_u32 v10, v10, v248, v249
    v_max3_u32 v10, v10, v250, v251
    v_cmp_eq_u32 vcc, -1, v10
    s_cbranch_vccz L_h1_ok
    s_add_u32 s67, s67, 1
    s_cmp_lt_u32 s67, 65536
    s_cbranch_scc1 L_h1_loop
    s_branch L_h1_ok
L_h2_retry:
    s_mov_b32 s67, 0
L_h2_loop:
    s_mov_b32 s44, m0
    s_add_u32 m0, s63, 0
    s_add_u32 s57, s62, 57344
    buffer_load_dwordx4 v11, s[4:7], s57 offen offset:0 sc1 lds
    buffer_load_dwordx4 v11, s[4:7], s57 offen offset:1024 sc1 lds
    buffer_load_dwordx4 v11, s[4:7], s57 offen offset:2048 sc1 lds
    buffer_load_dwordx4 v11, s[4:7], s57 offen offset:3072 sc1 lds
    s_add_u32 m0, s63, 4096
    s_add_u32 s57, s62, 61440
    buffer_load_dwordx4 v11, s[4:7], s57 offen offset:0 sc1 lds
    buffer_load_dwordx4 v11, s[4:7], s57 offen offset:1024 sc1 lds
    buffer_load_dwordx4 v11, s[4:7], s57 offen offset:2048 sc1 lds
    s_mov_b32 m0, s44
    s_waitcnt vmcnt(0) lgkmcnt(0)
    ds_read_b128 v[224:227], v2 offset:0
    ds_read_b128 v[228:231], v2 offset:1024
    ds_read_b128 v[232:235], v2 offset:2048
    ds_read_b128 v[236:239], v2 offset:3072
    ds_read_b128 v[240:243], v2 offset:4096
    ds_read_b128 v[244:247], v2 offset:5120
    ds_read_b128 v[248:251], v2 offset:6144
    s_waitcnt lgkmcnt(0)
    v_max3_u32 v10, v224, v225, v226
    v_max_u32 v10, v10, v227
    s_waitcnt lgkmcnt(0)
    v_max3_u32 v10, v10, v228, v229
    v_max3_u32 v10, v10, v230, v231
    s_waitcnt lgkmcnt(0)
    v_max3_u32 v10, v10, v232, v233
    v_max3_u32 v10, v10, v234, v235
    s_waitcnt lgkmcnt(0)
    v_max3_u32 v10, v10, v236, v237
    v_max3_u32 v10, v10, v238, v239
    s_waitcnt lgkmcnt(0)
    v_max3_u32 v10, v10, v240, v241
    v_max3_u32 v10, v10, v242, v243
    s_waitcnt lgkmcnt(0)
    v_max3_u32 v10, v10, v244, v245
    v_max3_u32 v10, v10, v246, v247
    s_waitcnt lgkmcnt(0)
    v_max3_u32 v10, v10, v248, v249
    v_max3_u32 v10, v10, v250, v251
    v_cmp_eq_u32 vcc, -1, v10
    s_cbranch_vccz L_h2_ok
    s_add_u32 s67, s67, 1
    s_cmp_lt_u32 s67, 65536
    s_cbranch_scc1 L_h2_loop
    s_branch L_h2_ok
L_h3_retry:
    s_mov_b32 s67, 0
L_h3_loop:
    s_mov_b32 s44, m0
    s_add_u32 m0, s63, 28672
    s_add_u32 s57, s62, 86016
    buffer_load_dwordx4 v11, s[4:7], s57 offen offset:0 sc1 lds
    buffer_load_dwordx4 v11, s[4:7], s57 offen offset:1024 sc1 lds
    buffer_load_dwordx4 v11, s[4:7], s57 offen offset:2048 sc1 lds
    buffer_load_dwordx4 v11, s[4:7], s57 offen offset:3072 sc1 lds
    s_add_u32 m0, s63, 32768
    s_add_u32 s57, s62, 90112
    buffer_load_dwordx4 v11, s[4:7], s57 offen offset:0 sc1 lds
    buffer_load_dwordx4 v11, s[4:7], s57 offen offset:1024 sc1 lds
    buffer_load_dwordx4 v11, s[4:7], s57 offen offset:2048 sc1 lds
    s_mov_b32 m0, s44
    s_waitcnt vmcnt(0) lgkmcnt(0)
    ds_read_b128 v[224:227], v2 offset:28672
    ds_read_b128 v[228:231], v2 offset:29696
    ds_read_b128 v[232:235], v2 offset:30720
    ds_read_b128 v[236:239], v2 offset:31744
    ds_read_b128 v[240:243], v2 offset:32768
    ds_read_b128 v[244:247], v2 offset:33792
    ds_read_b128 v[248:251], v2 offset:34816
    s_waitcnt lgkmcnt(0)
    v_max3_u32 v10, v224, v225, v226
    v_max_u32 v10, v10, v227
    s_waitcnt lgkmcnt(0)
    v_max3_u32 v10, v10, v228, v229
    v_max3_u32 v10, v10, v230, v231
    s_waitcnt lgkmcnt(0)
    v_max3_u32 v10, v10, v232, v233
    v_max3_u32 v10, v10, v234, v235
    s_waitcnt lgkmcnt(0)
    v_max3_u32 v10, v10, v236, v237
    v_max3_u32 v10, v10, v238, v239
    s_waitcnt lgkmcnt(0)
    v_max3_u32 v10, v10, v240, v241
    v_max3_u32 v10, v10, v242, v243
    s_waitcnt lgkmcnt(0)
    v_max3_u32 v10, v10, v244, v245
    v_max3_u32 v10, v10, v246, v247
    s_waitcnt lgkmcnt(0)
    v_max3_u32 v10, v10, v248, v249
    v_max3_u32 v10, v10, v250, v251
    v_cmp_eq_u32 vcc, -1, v10
    s_cbranch_vccz L_h3_ok
    s_add_u32 s67, s67, 1
    s_cmp_lt_u32 s67, 65536
    s_cbranch_scc1 L_h3_loop
    s_branch L_h3_ok
L_fc_retry:
    s_mov_b32 s67, 0
L_fc_loop:
    buffer_load_dwordx2 v[20:21], v9, s[4:7], 0 offen sc1
    s_waitcnt vmcnt(0) lgkmcnt(0)
    v_cmp_ne_u64 vcc, s[50:51], v[20:21]
    s_cbranch_vccz L_fc_ok
    s_add_u32 s67, s67, 1
    s_cmp_lt_u32 s67, 65536
    s_cbranch_scc1 L_fc_loop
    s_branch L_fc_ok
L_ft1_retry:
    s_mov_b32 s67, 0
L_ft1_loop:
    buffer_load_dwordx2 v[20:21], v3, s[4:7], 0 offen offset:8 sc1
    s_waitcnt vmcnt(0) lgkmcnt(0)
    v_cmp_ne_u64 vcc, s[50:51], v[20:21]
    s_cbranch_vccz L_ft1_ok
    s_add_u32 s67, s67, 1
    s_cmp_lt_u32 s67, 65536
    s_cbranch_scc1 L_ft1_loop
    s_branch L_ft1_ok
L_q2_0_retry:
    s_mov_b32 s67, 0
L_q2_0_loop:
    s_add_u32 s57, s65, 229376
    buffer_load_dwordx4 a[112:115], v11, s[4:7], s57 offen offset:0 sc1
    s_add_u32 s57, s65, 230400
    buffer_load_dwordx4 a[116:119], v11, s[4:7], s57 offen offset:0 sc1
    s_add_u32 s57, s65, 231424
    buffer_load_dwordx4 a[120:123], v11, s[4:7], s57 offen offset:0 sc1
    s_add_u32 s57, s65, 232448
    buffer_load_dwordx4 a[124:127], v11, s[4:7], s57 offen offset:0 sc1
    s_waitcnt vmcnt(0) lgkmcnt(0)
    v_accvgpr_read_b32 v16, a115
    v_accvgpr_read_b32 v17, a119
    v_accvgpr_read_b32 v18, a123
    v_accvgpr_read_b32 v19, a127
    v_max3_u32 v10, v16, v17, v18
    v_max_u32 v10, v10, v19
    v_cmp_eq_u32 vcc, -1, v10
    s_cbranch_vccz L_q2_0_ok
    s_add_u32 s67, s67, 1
    s_cmp_lt_u32 s67, 65536
    s_cbranch_scc1 L_q2_0_loop
    s_branch L_q2_0_ok
L_q2_4_retry:
    s_mov_b32 s67, 0
L_q2_4_loop:
    s_add_u32 s57, s65, 233472
    buffer_load_dwordx4 a[128:131], v11, s[4:7], s57 offen offset:0 sc1
    s_add_u32 s57, s65, 234496
    buffer_load_dwordx4 a[132:135], v11, s[4:7], s57 offen offset:0 sc1
    s_add_u32 s57, s65, 235520
    buffer_load_dwordx4 a[136:139], v11, s[4:7], s57 offen offset:0 sc1
    s_add_u32 s57, s65, 236544
    buffer_load_dwordx4 a[140:143], v11, s[4:7], s57 offen offset:0 sc1
    s_waitcnt vmcnt(0) lgkmcnt(0)
    v_accvgpr_read_b32 v16, a131
    v_accvgpr_read_b32 v17, a135
    v_accvgpr_read_b32 v18, a139
    v_accvgpr_read_b32 v19, a143
    v_max3_u32 v10, v16, v17, v18
    v_max_u32 v10, v10, v19
    v_cmp_eq_u32 vcc, -1, v10
    s_cbranch_vccz L_q2_4_ok
    s_add_u32 s67, s67, 1
    s_cmp_lt_u32 s67, 65536
    s_cbranch_scc1 L_q2_4_loop
    s_branch L_q2_4_ok
L_q2_8_retry:
    s_mov_b32 s67, 0
L_q2_8_loop:
    s_add_u32 s57, s65, 237568
    buffer_load_dwordx4 a[144:147], v11, s[4:7], s57 offen offset:0 sc1
    s_add_u32 s57, s65, 238592
    buffer_load_dwordx4 a[148:151], v11, s[4:7], s57 offen offset:0 sc1
    s_waitcnt vmcnt(0) lgkmcnt(0)
    v_accvgpr_read_b32 v16, a147
    v_accvgpr_read_b32 v17, a151
    v_max_u32 v10, v16, v17
    v_cmp_eq_u32 vcc, -1, v10
    s_cbranch_vccz L_q2_8_ok
    s_add_u32 s67, s67, 1
    s_cmp_lt_u32 s67, 65536
    s_cbranch_scc1 L_q2_8_loop
    s_branch L_q2_8_ok
L_q2_10_retry:
    s_mov_b32 s67, 0
L_q2_10_loop:
    s_add_u32 s57, s65, 239616
    buffer_load_dwordx4 a[152:155], v11, s[4:7], s57 offen offset:0 sc1
    s_add_u32 s57, s65, 240640
    buffer_load_dwordx4 a[156:159], v11, s[4:7], s57 offen offset:0 sc1
    s_add_u32 s57, s65, 241664
    buffer_load_dwordx4 a[160:163], v11, s[4:7], s57 offen offset:0 sc1
    s_add_u32 s57, s65, 242688
    buffer_load_dwordx4 a[164:167], v11, s[4:7], s57 offen offset:0 sc1
    s_waitcnt vmcnt(0) lgkmcnt(0)
    v_accvgpr_read_b32 v16, a155
    v_accvgpr_read_b32 v17, a159
    v_accvgpr_read_b32 v18, a163
    v_accvgpr_read_b32 v19, a167
    v_max3_u32 v10, v16, v17, v18
    v_max_u32 v10, v10, v19
    v_cmp_eq_u32 vcc, -1, v10
    s_cbranch_vccz L_q2_10_ok
    s_add_u32 s67, s67, 1
    s_cmp_lt_u32 s67, 65536
    s_cbranch_scc1 L_q2_10_loop
    s_branch L_q2_10_ok
L_q3_0_retry:
    s_mov_b32 s67, 0
L_q3_0_loop:
    s_add_u32 s57, s65, 344064
    buffer_load_dwordx4 a[0:3], v11, s[4:7], s57 offen offset:0 sc1
    s_add_u32 s57, s65, 345088
    buffer_load_dwordx4 a[4:7], v11, s[4:7], s57 offen offset:0 sc1
    s_add_u32 s57, s65, 346112
    buffer_load_dwordx4 a[8:11], v11, s[4:7], s57 offen offset:0 sc1
    s_add_u32 s57, s65, 347136
    buffer_load_dwordx4 a[12:15], v11, s[4:7], s57 offen offset:0 sc1
    s_waitcnt vmcnt(0) lgkmcnt(0)
    v_accvgpr_read_b32 v16, a3
    v_accvgpr_read_b32 v17, a7
    v_accvgpr_read_b32 v18, a11
    v_accvgpr_read_b32 v19, a15
    v_max3_u32 v10, v16, v17, v18
    v_max_u32 v10, v10, v19
    v_cmp_eq_u32 vcc, -1, v10
    s_cbranch_vccz L_q3_0_ok
    s_add_u32 s67, s67, 1
    s_cmp_lt_u32 s67, 65536
    s_cbranch_scc1 L_q3_0_loop
    s_branch L_q3_0_ok
L_q3_4_retry:
    s_mov_b32 s67, 0
L_q3_4_loop:
    s_add_u32 s57, s65, 348160
    buffer_load_dwordx4 a[16:19], v11, s[4:7], s57 offen offset:0 sc1
    s_add_u32 s57, s65, 349184
    buffer_load_dwordx4 a[20:23], v11, s[4:7], s57 offen offset:0 sc1
    s_add_u32 s57, s65, 350208
    buffer_load_dwordx4 a[24:27], v11, s[4:7], s57 offen offset:0 sc1
    s_add_u32 s57, s65, 351232
    buffer_load_dwordx4 a[28:31], v11, s[4:7], s57 offen offset:0 sc1
    s_waitcnt vmcnt(0) lgkmcnt(0)
    v_accvgpr_read_b32 v16, a19
    v_accvgpr_read_b32 v17, a23
    v_accvgpr_read_b32 v18, a27
    v_accvgpr_read_b32 v19, a31
    v_max3_u32 v10, v16, v17, v18
    v_max_u32 v10, v10, v19
    v_cmp_eq_u32 vcc, -1, v10
    s_cbranch_vccz L_q3_4_ok
    s_add_u32 s67, s67, 1
    s_cmp_lt_u32 s67, 65536
    s_cbranch_scc1 L_q3_4_loop
    s_branch L_q3_4_ok
L_q3_8_retry:
    s_mov_b32 s67, 0
L_q3_8_loop:
    s_add_u32 s57, s65, 352256
    buffer_load_dwordx4 a[32:35], v11, s[4:7], s57 offen offset:0 sc1
    s_add_u32 s57, s65, 353280
    buffer_load_dwordx4 a[36:39], v11, s[4:7], s57 offen offset:0 sc1
    s_waitcnt vmcnt(0) lgkmcnt(0)
    v_accvgpr_read_b32 v16, a35
    v_accvgpr_read_b32 v17, a39
    v_max_u32 v10, v16, v17
    v_cmp_eq_u32 vcc, -1, v10
    s_cbranch_vccz L_q3_8_ok
    s_add_u32 s67, s67, 1
    s_cmp_lt_u32 s67, 65536
    s_cbranch_scc1 L_q3_8_loop
    s_branch L_q3_8_ok
L_q3_10_retry:
    s_mov_b32 s67, 0
L_q3_10_loop:
    s_add_u32 s57, s65, 354304
    buffer_load_dwordx4 a[40:43], v11, s[4:7], s57 offen offset:0 sc1
    s_add_u32 s57, s65, 355328
    buffer_load_dwordx4 a[44:47], v11, s[4:7], s57 offen offset:0 sc1
    s_add_u32 s57, s65, 356352
    buffer_load_dwordx4 a[48:51], v11, s[4:7], s57 offen offset:0 sc1
    s_add_u32 s57, s65, 357376
    buffer_load_dwordx4 a[52:55], v11, s[4:7], s57 offen offset:0 sc1
    s_waitcnt vmcnt(0) lgkmcnt(0)
    v_accvgpr_read_b32 v16, a43
    v_accvgpr_read_b32 v17, a47
    v_accvgpr_read_b32 v18, a51
    v_accvgpr_read_b32 v19, a55
    v_max3_u32 v10, v16, v17, v18
    v_max_u32 v10, v10, v19
    v_cmp_eq_u32 vcc, -1, v10
    s_cbranch_vccz L_q3_10_ok
    s_add_u32 s67, s67, 1
    s_cmp_lt_u32 s67, 65536
    s_cbranch_scc1 L_q3_10_loop
    s_branch L_q3_10_ok
L_g2_nan:
    s_mov_b32 s67, 0
    s_add_u32 s57, s65, 229376
    s_add_u32 s44, s57, 14336
L_g2_next:
    buffer_load_dwordx4 v[32:35], v11, s[4:7], s57 offen sc1
    s_waitcnt vmcnt(0) lgkmcnt(0)
    v_max3_u32 v32, v32, v33, v34
    v_max_u32 v32, v32, v35
    v_cmp_eq_u32 vcc, -1, v32
    s_cbranch_vccz L_g2_adv
    s_add_u32 s67, s67, 1
    s_cmp_lt_u32 s67, 65536
    s_cbranch_scc1 L_g2_next
L_g2_adv:
    s_add_u32 s57, s57, 1024
    s_cmp_lt_u32 s57, s44
    s_cbranch_scc1 L_g2_next
    s_add_u32 s57, s65, 229376
    buffer_load_dwordx4 a[112:115], v11, s[4:7], s57 offen offset:0 sc1
    buffer_load_dwordx4 a[116:119], v11, s[4:7], s57 offen offset:1024 sc1
    buffer_load_dwordx4 a[120:123], v11, s[4:7], s57 offen offset:2048 sc1
    buffer_load_dwordx4 a[124:127], v11, s[4:7], s57 offen offset:3072 sc1
    s_add_u32 s57, s65, 233472
    buffer_load_dwordx4 a[128:131], v11, s[4:7], s57 offen offset:0 sc1
    buffer_load_dwordx4 a[132:135], v11, s[4:7], s57 offen offset:1024 sc1
    buffer_load_dwordx4 a[136:139], v11, s[4:7], s57 offen offset:2048 sc1
    buffer_load_dwordx4 a[140:143], v11, s[4:7], s57 offen offset:3072 sc1
    s_add_u32 s57, s65, 237568
    buffer_load_dwordx4 a[144:147], v11, s[4:7], s57 offen offset:0 sc1
    buffer_load_dwordx4 a[148:151], v11, s[4:7], s57 offen offset:1024 sc1
    buffer_load_dwordx4 a[152:155], v11, s[4:7], s57 offen offset:2048 sc1
    buffer_load_dwordx4 a[156:159], v11, s[4:7], s57 offen offset:3072 sc1
    s_add_u32 s57, s65, 241664
    buffer_load_dwordx4 a[160:163], v11, s[4:7], s57 offen offset:0 sc1
    buffer_load_dwordx4 a[164:167], v11, s[4:7], s57 offen offset:1024 sc1
    s_waitcnt vmcnt(0)
    v_mfma_f32_16x16x32_bf16 v[80:83], a[224:227], a[112:115], 0
    v_mfma_f32_16x16x32_bf16 v[80:83], a[240:243], a[116:119], v[80:83]
    v_mfma_f32_16x16x32_bf16 v[84:87], a[228:231], a[112:115], 0
    v_mfma_f32_16x16x32_bf16 v[84:87], a[244:247], a[116:119], v[84:87]
    v_mfma_f32_16x16x32_bf16 v[88:91], a[232:235], a[112:115], 0
    v_mfma_f32_16x16x32_bf16 v[88:91], a[248:251], a[116:119], v[88:91]
    v_mfma_f32_16x16x32_bf16 v[92:95], a[236:239], a[112:115], 0
    v_mfma_f32_16x16x32_bf16 v[92:95], a[252:255], a[116:119], v[92:95]
    v_mfma_f32_16x16x32_bf16 v[80:83], v[112:115], a[120:123], v[80:83]
    v_mfma_f32_16x16x32_bf16 v[80:83], v[128:131], a[124:127], v[80:83]
    v_mfma_f32_16x16x32_bf16 v[84:87], v[116:119], a[120:123], v[84:87]
    v_mfma_f32_16x16x32_bf16 v[84:87], v[132:135], a[124:127], v[84:87]
    v_mfma_f32_16x16x32_bf16 v[88:91], v[120:123], a[120:123], v[88:91]
    v_mfma_f32_16x16x32_bf16 v[88:91], v[136:139], a[124:127], v[88:91]
    v_mfma_f32_16x16x32_bf16 v[92:95], v[124:127], a[120:123], v[92:95]
    v_mfma_f32_16x16x32_bf16 v[92:95], v[140:143], a[124:127], v[92:95]
    v_mfma_f32_16x16x32_bf16 v[80:83], v[144:147], a[128:131], v[80:83]
    v_mfma_f32_16x16x32_bf16 v[80:83], v[160:163], a[132:135], v[80:83]
    v_mfma_f32_16x16x32_bf16 v[84:87], v[148:151], a[128:131], v[84:87]
    v_mfma_f32_16x16x32_bf16 v[84:87], v[164:167], a[132:135], v[84:87]
    v_mfma_f32_16x16x32_bf16 v[88:91], v[152:155], a[128:131], v[88:91]
    v_mfma_f32_16x16x32_bf16 v[88:91], v[168:171], a[132:135], v[88:91]
    v_mfma_f32_16x16x32_bf16 v[92:95], v[156:159], a[128:131], v[92:95]
    v_mfma_f32_16x16x32_bf16 v[92:95], v[172:175], a[132:135], v[92:95]
    v_mfma_f32_16x16x32_bf16 v[80:83], v[176:179], a[136:139], v[80:83]
    v_mfma_f32_16x16x32_bf16 v[80:83], v[192:195], a[140:143], v[80:83]
    v_mfma_f32_16x16x32_bf16 v[84:87], v[180:183], a[136:139], v[84:87]
    v_mfma_f32_16x16x32_bf16 v[84:87], v[196:199], a[140:143], v[84:87]
    v_mfma_f32_16x16x32_bf16 v[88:91], v[184:187], a[136:139], v[88:91]
    v_mfma_f32_16x16x32_bf16 v[88:91], v[200:203], a[140:143], v[88:91]
    v_mfma_f32_16x16x32_bf16 v[92:95], v[188:191], a[136:139], v[92:95]
    v_mfma_f32_16x16x32_bf16 v[92:95], v[204:207], a[140:143], v[92:95]
    v_mfma_f32_16x16x32_bf16 v[80:83], v[208:211], a[144:147], v[80:83]
    v_mfma_f32_16x16x32_bf16 v[80:83], v[224:227], a[148:151], v[80:83]
    v_mfma_f32_16x16x32_bf16 v[84:87], v[212:215], a[144:147], v[84:87]
    v_mfma_f32_16x16x32_bf16 v[84:87], v[228:231], a[148:151], v[84:87]
    v_mfma_f32_16x16x32_bf16 v[88:91], v[216:219], a[144:147], v[88:91]
    v_mfma_f32_16x16x32_bf16 v[88:91], v[232:235], a[148:151], v[88:91]
    v_mfma_f32_16x16x32_bf16 v[92:95], v[220:223], a[144:147], v[92:95]
    v_mfma_f32_16x16x32_bf16 v[92:95], v[236:239], a[148:151], v[92:95]
    v_mfma_f32_16x16x32_bf16 v[80:83], v[240:243], a[152:155], v[80:83]
    v_mfma_f32_16x16x32_bf16 v[80:83], a[168:171], a[156:159], v[80:83]
    v_mfma_f32_16x16x32_bf16 v[80:83], a[184:187], a[160:163], v[80:83]
    v_mfma_f32_16x16x32_bf16 v[80:83], a[200:203], a[164:167], v[80:83]
    v_mfma_f32_16x16x32_bf16 v[84:87], v[244:247], a[152:155], v[84:87]
    v_mfma_f32_16x16x32_bf16 v[84:87], a[172:175], a[156:159], v[84:87]
    v_mfma_f32_16x16x32_bf16 v[84:87], a[188:191], a[160:163], v[84:87]
    v_mfma_f32_16x16x32_bf16 v[84:87], a[204:207], a[164:167], v[84:87]
    v_mfma_f32_16x16x32_bf16 v[88:91], v[248:251], a[152:155], v[88:91]
    v_mfma_f32_16x16x32_bf16 v[88:91], a[176:179], a[156:159], v[88:91]
    v_mfma_f32_16x16x32_bf16 v[88:91], a[192:195], a[160:163], v[88:91]
    v_mfma_f32_16x16x32_bf16 v[88:91], a[208:211], a[164:167], v[88:91]
    v_mfma_f32_16x16x32_bf16 v[92:95], v[252:255], a[152:155], v[92:95]
    v_mfma_f32_16x16x32_bf16 v[92:95], a[180:183], a[156:159], v[92:95]
    v_mfma_f32_16x16x32_bf16 v[92:95], a[196:199], a[160:163], v[92:95]
    v_mfma_f32_16x16x32_bf16 v[92:95], a[212:215], a[164:167], v[92:95]
    s_nop 7
    ds_write_b128 v2, v[80:83] offset:34816
    ds_write_b128 v2, v[84:87] offset:34880
    ds_write_b128 v2, v[88:91] offset:34944
    s_branch L_g2_ok
L_g3_nan:
    s_mov_b32 s67, 0
    s_add_u32 s57, s65, 344064
    s_add_u32 s44, s57, 14336
L_g3_next:
    buffer_load_dwordx4 v[32:35], v11, s[4:7], s57 offen sc1
    s_waitcnt vmcnt(0) lgkmcnt(0)
    v_max3_u32 v32, v32, v33, v34
    v_max_u32 v32, v32, v35
    v_cmp_eq_u32 vcc, -1, v32
    s_cbranch_vccz L_g3_adv
    s_add_u32 s67, s67, 1
    s_cmp_lt_u32 s67, 65536
    s_cbranch_scc1 L_g3_next
L_g3_adv:
    s_add_u32 s57, s57, 1024
    s_cmp_lt_u32 s57, s44
    s_cbranch_scc1 L_g3_next
    s_add_u32 s57, s65, 344064
    buffer_load_dwordx4 a[0:3], v11, s[4:7], s57 offen offset:0 sc1
    buffer_load_dwordx4 a[4:7], v11, s[4:7], s57 offen offset:1024 sc1
    buffer_load_dwordx4 a[8:11], v11, s[4:7], s57 offen offset:2048 sc1
    buffer_load_dwordx4 a[12:15], v11, s[4:7], s57 offen offset:3072 sc1
    s_add_u32 s57, s65, 348160
    buffer_load_dwordx4 a[16:19], v11, s[4:7], s57 offen offset:0 sc1
    buffer_load_dwordx4 a[20:23], v11, s[4:7], s57 offen offset:1024 sc1
    buffer_load_dwordx4 a[24:27], v11, s[4:7], s57 offen offset:2048 sc1
    buffer_load_dwordx4 a[28:31], v11, s[4:7], s57 offen offset:3072 sc1
    s_add_u32 s57, s65, 352256
    buffer_load_dwordx4 a[32:35], v11, s[4:7], s57 offen offset:0 sc1
    buffer_load_dwordx4 a[36:39], v11, s[4:7], s57 offen offset:1024 sc1
    buffer_load_dwordx4 a[40:43], v11, s[4:7], s57 offen offset:2048 sc1
    buffer_load_dwordx4 a[44:47], v11, s[4:7], s57 offen offset:3072 sc1
    s_add_u32 s57, s65, 356352
    buffer_load_dwordx4 a[48:51], v11, s[4:7], s57 offen offset:0 sc1
    buffer_load_dwordx4 a[52:55], v11, s[4:7], s57 offen offset:1024 sc1
    s_waitcnt vmcnt(0)
    v_mfma_f32_16x16x32_bf16 v[96:99], a[224:227], a[0:3], 0
    v_mfma_f32_16x16x32_bf16 v[96:99], a[240:243], a[4:7], v[96:99]
    v_mfma_f32_16x16x32_bf16 v[100:103], a[228:231], a[0:3], 0
    v_mfma_f32_16x16x32_bf16 v[100:103], a[244:247], a[4:7], v[100:103]
    v_mfma_f32_16x16x32_bf16 v[104:107], a[232:235], a[0:3], 0
    v_mfma_f32_16x16x32_bf16 v[104:107], a[248:251], a[4:7], v[104:107]
    v_mfma_f32_16x16x32_bf16 v[108:111], a[236:239], a[0:3], 0
    v_mfma_f32_16x16x32_bf16 v[108:111], a[252:255], a[4:7], v[108:111]
    v_mfma_f32_16x16x32_bf16 v[96:99], v[112:115], a[8:11], v[96:99]
    v_mfma_f32_16x16x32_bf16 v[96:99], v[128:131], a[12:15], v[96:99]
    v_mfma_f32_16x16x32_bf16 v[100:103], v[116:119], a[8:11], v[100:103]
    v_mfma_f32_16x16x32_bf16 v[100:103], v[132:135], a[12:15], v[100:103]
    v_mfma_f32_16x16x32_bf16 v[104:107], v[120:123], a[8:11], v[104:107]
    v_mfma_f32_16x16x32_bf16 v[104:107], v[136:139], a[12:15], v[104:107]
    v_mfma_f32_16x16x32_bf16 v[108:111], v[124:127], a[8:11], v[108:111]
    v_mfma_f32_16x16x32_bf16 v[108:111], v[140:143], a[12:15], v[108:111]
    v_mfma_f32_16x16x32_bf16 v[96:99], v[144:147], a[16:19], v[96:99]
    v_mfma_f32_16x16x32_bf16 v[96:99], v[160:163], a[20:23], v[96:99]
    v_mfma_f32_16x16x32_bf16 v[100:103], v[148:151], a[16:19], v[100:103]
    v_mfma_f32_16x16x32_bf16 v[100:103], v[164:167], a[20:23], v[100:103]
    v_mfma_f32_16x16x32_bf16 v[104:107], v[152:155], a[16:19], v[104:107]
    v_mfma_f32_16x16x32_bf16 v[104:107], v[168:171], a[20:23], v[104:107]
    v_mfma_f32_16x16x32_bf16 v[108:111], v[156:159], a[16:19], v[108:111]
    v_mfma_f32_16x16x32_bf16 v[108:111], v[172:175], a[20:23], v[108:111]
    v_mfma_f32_16x16x32_bf16 v[96:99], v[176:179], a[24:27], v[96:99]
    v_mfma_f32_16x16x32_bf16 v[96:99], v[192:195], a[28:31], v[96:99]
    v_mfma_f32_16x16x32_bf16 v[100:103], v[180:183], a[24:27], v[100:103]
    v_mfma_f32_16x16x32_bf16 v[100:103], v[196:199], a[28:31], v[100:103]
    v_mfma_f32_16x16x32_bf16 v[104:107], v[184:187], a[24:27], v[104:107]
    v_mfma_f32_16x16x32_bf16 v[104:107], v[200:203], a[28:31], v[104:107]
    v_mfma_f32_16x16x32_bf16 v[108:111], v[188:191], a[24:27], v[108:111]
    v_mfma_f32_16x16x32_bf16 v[108:111], v[204:207], a[28:31], v[108:111]
    v_mfma_f32_16x16x32_bf16 v[96:99], v[208:211], a[32:35], v[96:99]
    v_mfma_f32_16x16x32_bf16 v[96:99], v[224:227], a[36:39], v[96:99]
    v_mfma_f32_16x16x32_bf16 v[100:103], v[212:215], a[32:35], v[100:103]
    v_mfma_f32_16x16x32_bf16 v[100:103], v[228:231], a[36:39], v[100:103]
    v_mfma_f32_16x16x32_bf16 v[104:107], v[216:219], a[32:35], v[104:107]
    v_mfma_f32_16x16x32_bf16 v[104:107], v[232:235], a[36:39], v[104:107]
    v_mfma_f32_16x16x32_bf16 v[108:111], v[220:223], a[32:35], v[108:111]
    v_mfma_f32_16x16x32_bf16 v[108:111], v[236:239], a[36:39], v[108:111]
    v_mfma_f32_16x16x32_bf16 v[96:99], v[240:243], a[40:43], v[96:99]
    v_mfma_f32_16x16x32_bf16 v[96:99], a[168:171], a[44:47], v[96:99]
    v_mfma_f32_16x16x32_bf16 v[96:99], a[184:187], a[48:51], v[96:99]
    v_mfma_f32_16x16x32_bf16 v[96:99], a[200:203], a[52:55], v[96:99]
    v_mfma_f32_16x16x32_bf16 v[100:103], v[244:247], a[40:43], v[100:103]
    v_mfma_f32_16x16x32_bf16 v[100:103], a[172:175], a[44:47], v[100:103]
    v_mfma_f32_16x16x32_bf16 v[100:103], a[188:191], a[48:51], v[100:103]
    v_mfma_f32_16x16x32_bf16 v[100:103], a[204:207], a[52:55], v[100:103]
    v_mfma_f32_16x16x32_bf16 v[104:107], v[248:251], a[40:43], v[104:107]
    v_mfma_f32_16x16x32_bf16 v[104:107], a[176:179], a[44:47], v[104:107]
    v_mfma_f32_16x16x32_bf16 v[104:107], a[192:195], a[48:51], v[104:107]
    v_mfma_f32_16x16x32_bf16 v[104:107], a[208:211], a[52:55], v[104:107]
    v_mfma_f32_16x16x32_bf16 v[108:111], v[252:255], a[40:43], v[108:111]
    v_mfma_f32_16x16x32_bf16 v[108:111], a[180:183], a[44:47], v[108:111]
    v_mfma_f32_16x16x32_bf16 v[108:111], a[196:199], a[48:51], v[108:111]
    v_mfma_f32_16x16x32_bf16 v[108:111], a[212:215], a[52:55], v[108:111]
    s_nop 7
    ds_write_b128 v2, v[96:99] offset:0
    ds_write_b128 v2, v[100:103] offset:64
    ds_write_b128 v2, v[104:107] offset:128
    s_branch L_g3_ok
L_code_end:
    s_endpgm
.fill 2048, 4, 0xbf810000
.section .rodata,"a"
.p2align 6
.amdhsa_kernel adaLN_cond__ssm_conv_h3__glu_gated_bilinear__prompt_kernel
  .amdhsa_next_free_vgpr 512
  .amdhsa_next_free_sgpr 102
  .amdhsa_accum_offset 256
  .amdhsa_group_segment_fixed_size 0
  .amdhsa_kernarg_size 120
  .amdhsa_user_sgpr_count 2
  .amdhsa_user_sgpr_kernarg_segment_ptr 1
  .amdhsa_system_sgpr_workgroup_id_x 1
  .amdhsa_float_denorm_mode_32 3
.end_amdhsa_kernel
```
